```python
import torch

def _softmax(x, axis=-1):
    return torch.softmax(x, dim=axis)
def _gelu(x):
    return torch.nn.functional.gelu(x, approximate="tanh")
def _silu(x):
    return torch.nn.functional.silu(x)
def _sigmoid(x):
    return torch.sigmoid(x)
def _layernorm(x, axis=-1, eps=1e-5):
    m = x.mean(dim=axis, keepdim=True)
    v = x.var(dim=axis, keepdim=True, unbiased=False)
    return (x - m) / torch.sqrt(v + eps)
def _scatter_add(tgt, idx, src, axis=0):
    return tgt.clone().index_add_(axis, idx, src)
def _segment_sum(src, seg, n):
    out = torch.zeros((n,) + src.shape[1:], dtype=src.dtype)
    return out.index_add_(0, seg, src)
def _pad(x, pw):
    flat = tuple(v for pair in reversed(pw) for v in pair)
    return torch.nn.functional.pad(x, flat)

kernel_name = 'concat_heads__softmax_full_mha__mha_block__prompt'

def setup_inputs():

    _w = (lambda a: (lambda t: t.to(torch.bfloat16) if t.is_floating_point() else t)(torch.as_tensor(a)))
    def _A_setup():
        B, S, D = 1, 2048, 1024
        return {
            "x": _w((lambda *s: torch.randn(*s, dtype=torch.bfloat16) * 0.2)(B, S, D)),
            "wqkv": _w((lambda *s: torch.randn(*s, dtype=torch.bfloat16) * 0.2)(D, 3 * D)),
            "wo": _w((lambda *s: torch.randn(*s, dtype=torch.bfloat16) * 0.05)(D, D)),
        }
    _A_in = _A_setup()

    def _B_setup():
        B, S, D, H = 1, 2048, 1024, 32
        return {
            "x": _w((lambda *s: torch.randn(*s, dtype=torch.bfloat16) * 0.2)(B, S, D)),
            "wqkv": _w((lambda *s: torch.randn(*s, dtype=torch.bfloat16) * 0.2)(D, 3 * D)),
            "wo": _w((lambda *s: torch.randn(*s, dtype=torch.bfloat16) * 0.05)(D, D)),
        }
    _B_in = _B_setup()

    return {
        "A_x": _A_in["x"],
        "A_wqkv": _A_in["wqkv"],
        "A_wo": _A_in["wo"],
        "B_x": _B_in["x"],
        "B_wqkv": _B_in["wqkv"],
        "B_wo": _B_in["wo"],
    }

def reference(A_x, A_wqkv, A_wo, B_x, B_wqkv, B_wo):
    def _A_ref(x, wqkv, wo):
        B, S, D = x.shape
        H = 32; Dh = D // H
        qkv = (lambda x, *d: x.permute(*d))((x @ wqkv).reshape(B, S, 3, H, Dh), 2, 0, 3, 1, 4)
        q, k, v = qkv[0], qkv[1], qkv[2]
        scale = Dh ** -0.5
        scores = torch.einsum("bhqd,bhkd->bhqk", q, k) * scale
        p = _softmax(scores, axis=-1)
        o = torch.einsum("bhqk,bhkd->bhqd", p, v)
        return (lambda x, *d: x.permute(*d))(o, 0, 2, 1, 3).reshape(B, S, D) @ wo

    def _B_ref(x, wqkv, wo):
        B, S, D = x.shape
        H = 32
        Dh = D // H
        qkv = (lambda x, *d: x.permute(*d))((x @ wqkv).reshape(B, S, 3, H, Dh), 2, 0, 3, 1, 4)
        q, k, v = qkv[0], qkv[1], qkv[2]
        scores = torch.einsum("bhqd,bhkd->bhqk", q, k) * (Dh ** -0.5)
        p = _softmax(scores, axis=-1)
        o = torch.einsum("bhqk,bhkd->bhqd", p, v)
        return (lambda x, *d: x.permute(*d))(o, 0, 2, 1, 3).reshape(B, S, D) @ wo

    a = _A_ref(A_x, A_wqkv, A_wo)
    b = _B_ref(B_x, B_wqkv, B_wo)
    return torch.concatenate([a, b], axis=-1)
```

```asm
; @launch grid=(256,1,1) block=(768,1,1) lds=163840
.amdgcn_target "amdgcn-amd-amdhsa--gfx950"
.text
.globl concat_heads__softmax_full_mha__mha_block__prompt_kernel
.p2align 8
.type concat_heads__softmax_full_mha__mha_block__prompt_kernel,@function
concat_heads__softmax_full_mha__mha_block__prompt_kernel:
    s_cmp_ge_u32 s2, 256
    s_cbranch_scc1 concat_heads__softmax_full_mha__mha_block__prompt_kernel_end
    s_getpc_b64 s[48:49]
concat_heads__softmax_full_mha__mha_block__prompt_kernel_pc0:
    s_mov_b32 s50, concat_heads__softmax_full_mha__mha_block__prompt_kernel_slow-concat_heads__softmax_full_mha__mha_block__prompt_kernel_pc0
    s_mov_b32 s51, 0x20000
    v_lshlrev_b32 v166, 7, v0
    buffer_load_dword v167, v166, s[48:51], 0 offen
    s_and_b32 s22, s2, 7
    s_lshr_b32 s19, s22, 2
    s_mul_i32 s23, s19, 24
    s_add_u32 s10, s0, s23
    s_addc_u32 s11, s1, 0
    s_load_dwordx4 s[4:7], s[10:11], 0
    s_load_dwordx2 s[8:9], s[10:11], 16
    s_load_dwordx4 s[12:15], s[0:1], 48
    s_load_dwordx2 s[16:17], s[0:1], 64
    v_lshrrev_b32 v1, 6, v0
    v_and_b32 v0, 63, v0
    v_readfirstlane_b32 s18, v1
    s_and_b32 s22, s22, 3
    s_lshl_b32 s22, s22, 2
    s_lshr_b32 s23, s2, 3
    s_lshr_b32 s21, s23, 2
    s_and_b32 s23, s23, 3
    s_add_u32 s20, s22, s23
    s_cmp_lt_u32 s18, 8
    s_cbranch_scc1 concat_heads__softmax_full_mha__mha_block__prompt_kernel_compute
    s_sub_u32 s39, s18, 8
    s_setprio 3
    s_and_b32 s22, s39, 1
    s_lshl_b32 s23, s22, 2
    v_lshrrev_b32 v5, 4, v0
    v_add_u32 v5, s23, v5
    v_and_b32 v6, 7, v0
    v_xor_b32 v5, v5, v6
    v_lshlrev_b32 v5, 4, v5
    v_lshrrev_b32 v7, 3, v0
    s_lshl_b32 s23, s39, 3
    v_add_u32 v7, s23, v7
    v_lshl_add_u32 v2, v7, 11, v5
    v_bfe_u32 v5, v0, 4, 1
    s_lshl_b32 s22, s22, 1
    v_or_b32 v5, s22, v5
    v_lshlrev_b32 v5, 1, v5
    v_xor_b32 v5, v5, v6
    v_lshlrev_b32 v5, 4, v5
    v_mul_u32_u24 v7, 6144, v7
    v_add_u32 v3, v7, v5
    s_lshl_b32 s36, s39, 10
    s_lshl_b32 s32, s21, 19
    s_lshl_b32 s33, s20, 7
    s_mov_b32 s34, s36
    s_add_u32 s35, s36, 98304
    s_mov_b32 s26, 4194304
    s_mov_b32 s27, 0x20000
    s_mov_b32 s30, 6291456
    s_mov_b32 s31, 0x20000
    s_waitcnt lgkmcnt(0)
    s_mov_b64 s[24:25], s[4:5]
    s_mov_b64 s[28:29], s[6:7]
    s_mov_b32 s40, 15
    s_branch concat_heads__softmax_full_mha__mha_block__prompt_kernel_l1body
concat_heads__softmax_full_mha__mha_block__prompt_kernel_l1loop:
    s_waitcnt vmcnt(8)
    s_barrier
concat_heads__softmax_full_mha__mha_block__prompt_kernel_l1body:
    s_add_u32 m0, s35, 0
    s_add_u32 s22, s33, 0
    buffer_load_dwordx4 v3, s[28:31], s22 offen lds
    s_add_u32 m0, s35, 4096
    s_add_u32 s22, s33, 2048
    buffer_load_dwordx4 v3, s[28:31], s22 offen lds
    s_add_u32 m0, s35, 8192
    s_add_u32 s22, s33, 4096
    buffer_load_dwordx4 v3, s[28:31], s22 offen lds
    s_add_u32 s35, s35, 12288
    s_sub_u32 s22, s35, 61440
    s_cmp_ge_u32 s35, 159744
    s_cselect_b32 s35, s22, s35
    s_add_u32 m0, s35, 0
    s_add_u32 s22, s33, 196608
    buffer_load_dwordx4 v3, s[28:31], s22 offen lds
    s_add_u32 m0, s35, 4096
    s_add_u32 s22, s33, 198656
    buffer_load_dwordx4 v3, s[28:31], s22 offen lds
    s_add_u32 m0, s35, 8192
    s_add_u32 s22, s33, 200704
    buffer_load_dwordx4 v3, s[28:31], s22 offen lds
    s_add_u32 s35, s35, 12288
    s_sub_u32 s22, s35, 61440
    s_cmp_ge_u32 s35, 159744
    s_cselect_b32 s35, s22, s35
    s_add_u32 s33, s33, 393216
    s_add_u32 m0, s34, 0
    s_add_u32 s22, s32, 0
    buffer_load_dwordx4 v2, s[24:27], s22 offen lds
    s_add_u32 m0, s34, 4096
    s_add_u32 s22, s32, 65536
    buffer_load_dwordx4 v2, s[24:27], s22 offen lds
    s_add_u32 m0, s34, 8192
    s_add_u32 s22, s32, 131072
    buffer_load_dwordx4 v2, s[24:27], s22 offen lds
    s_add_u32 m0, s34, 12288
    s_add_u32 s22, s32, 196608
    buffer_load_dwordx4 v2, s[24:27], s22 offen lds
    s_add_u32 m0, s34, 16384
    s_add_u32 s22, s32, 262144
    buffer_load_dwordx4 v2, s[24:27], s22 offen lds
    s_add_u32 m0, s34, 20480
    s_add_u32 s22, s32, 327680
    buffer_load_dwordx4 v2, s[24:27], s22 offen lds
    s_add_u32 m0, s34, 24576
    s_add_u32 s22, s32, 393216
    buffer_load_dwordx4 v2, s[24:27], s22 offen lds
    s_add_u32 m0, s34, 28672
    s_add_u32 s22, s32, 458752
    buffer_load_dwordx4 v2, s[24:27], s22 offen lds
    s_add_u32 s32, s32, 128
    s_add_u32 s34, s34, 32768
    s_cmp_ge_u32 s34, 98304
    s_cselect_b32 s34, s36, s34
    s_sub_u32 s40, s40, 1
    s_cmp_lt_u32 s40, 13
    s_cbranch_scc1 concat_heads__softmax_full_mha__mha_block__prompt_kernel_l1chk
    s_cmp_eq_u32 s40, 13
    s_cbranch_scc1 concat_heads__softmax_full_mha__mha_block__prompt_kernel_l1x2
    s_branch concat_heads__softmax_full_mha__mha_block__prompt_kernel_l1body
concat_heads__softmax_full_mha__mha_block__prompt_kernel_l1x2:
    s_waitcnt vmcnt(14)
    s_barrier
    s_add_u32 m0, s34, 0
    s_add_u32 s22, s32, 0
    buffer_load_dwordx4 v2, s[24:27], s22 offen lds
    s_add_u32 m0, s34, 4096
    s_add_u32 s22, s32, 65536
    buffer_load_dwordx4 v2, s[24:27], s22 offen lds
    s_add_u32 m0, s34, 8192
    s_add_u32 s22, s32, 131072
    buffer_load_dwordx4 v2, s[24:27], s22 offen lds
    s_add_u32 m0, s34, 12288
    s_add_u32 s22, s32, 196608
    buffer_load_dwordx4 v2, s[24:27], s22 offen lds
    s_add_u32 m0, s34, 16384
    s_add_u32 s22, s32, 262144
    buffer_load_dwordx4 v2, s[24:27], s22 offen lds
    s_add_u32 m0, s34, 20480
    s_add_u32 s22, s32, 327680
    buffer_load_dwordx4 v2, s[24:27], s22 offen lds
    s_add_u32 m0, s34, 24576
    s_add_u32 s22, s32, 393216
    buffer_load_dwordx4 v2, s[24:27], s22 offen lds
    s_add_u32 m0, s34, 28672
    s_add_u32 s22, s32, 458752
    buffer_load_dwordx4 v2, s[24:27], s22 offen lds
    s_add_u32 s32, s32, 128
    s_add_u32 s34, s34, 32768
    s_cmp_ge_u32 s34, 98304
    s_cselect_b32 s34, s36, s34
concat_heads__softmax_full_mha__mha_block__prompt_kernel_l1chk:
    s_cmp_lg_u32 s40, 0
    s_cbranch_scc1 concat_heads__softmax_full_mha__mha_block__prompt_kernel_l1loop
    s_waitcnt vmcnt(8)
    s_barrier
    s_add_u32 m0, s35, 0
    s_add_u32 s22, s33, 0
    buffer_load_dwordx4 v3, s[28:31], s22 offen lds
    s_add_u32 m0, s35, 4096
    s_add_u32 s22, s33, 2048
    buffer_load_dwordx4 v3, s[28:31], s22 offen lds
    s_add_u32 m0, s35, 8192
    s_add_u32 s22, s33, 4096
    buffer_load_dwordx4 v3, s[28:31], s22 offen lds
    s_add_u32 s35, s35, 12288
    s_sub_u32 s22, s35, 61440
    s_cmp_ge_u32 s35, 159744
    s_cselect_b32 s35, s22, s35
    s_add_u32 m0, s35, 0
    s_add_u32 s22, s33, 196608
    buffer_load_dwordx4 v3, s[28:31], s22 offen lds
    s_add_u32 m0, s35, 4096
    s_add_u32 s22, s33, 198656
    buffer_load_dwordx4 v3, s[28:31], s22 offen lds
    s_add_u32 m0, s35, 8192
    s_add_u32 s22, s33, 200704
    buffer_load_dwordx4 v3, s[28:31], s22 offen lds
    s_add_u32 s35, s35, 12288
    s_sub_u32 s22, s35, 61440
    s_cmp_ge_u32 s35, 159744
    s_cselect_b32 s35, s22, s35
    s_add_u32 s33, s33, 393216
    v_lshlrev_b32 v4, 4, v0
    v_mov_b32 v10, 0
    s_mov_b32 s46, 524288
concat_heads__softmax_full_mha__mha_block__prompt_kernel_non_l:
    global_load_dwordx2 v[8:9], v10, s[14:15] sc1
    s_waitcnt vmcnt(0)
    v_readfirstlane_b32 s42, v8
    v_readfirstlane_b32 s43, v9
    s_sub_u32 s46, s46, 1
    s_cmp_eq_u32 s46, 0
    s_cbranch_scc1 concat_heads__softmax_full_mha__mha_block__prompt_kernel_non_l_x
    s_cmp_eq_u32 s42, 0
    s_cbranch_scc1 concat_heads__softmax_full_mha__mha_block__prompt_kernel_non_l
concat_heads__softmax_full_mha__mha_block__prompt_kernel_non_l_x:
    s_barrier
    s_lshl_b32 s22, s19, 4
    s_add_u32 s22, s22, s20
    s_lshl_b32 s37, s22, 11
    s_lshl_b32 s22, s22, 19
    s_add_u32 s22, s22, 8388608
    s_add_u32 s24, s16, s22
    s_addc_u32 s25, s17, 0
    s_mov_b32 s26, 524288
    s_mov_b32 s27, 0x20000
    s_add_u32 s37, s37, 37748736
    s_add_u32 s44, s16, s37
    s_addc_u32 s45, s17, 0
    v_add_u32 v2, s36, v4
    v_and_b32 v5, 15, v0
    v_lshlrev_b32 v5, 7, v5
    s_and_b32 s33, s39, 1
    s_lshl_b32 s32, s21, 15
    s_cmp_ge_u32 s39, 2
    s_cbranch_scc1 concat_heads__softmax_full_mha__mha_block__prompt_kernel_fetch
    s_lshl_b32 s22, s33, 15
    s_add_u32 s22, s22, 32768
    v_add_u32 v3, s22, v4
    s_lshl_b32 s34, s33, 18
    s_add_u32 s34, s34, s32
    s_lshl_b32 s38, s33, 3
    s_add_u32 s38, s38, s21
    s_lshl_b32 s38, s38, 7
    s_barrier
    ds_read_b128 v[12:15], v3 offset:0
    ds_read_b128 v[16:19], v3 offset:1024
    ds_read_b128 v[20:23], v3 offset:2048
    ds_read_b128 v[24:27], v3 offset:3072
    ds_read_b128 v[28:31], v3 offset:4096
    ds_read_b128 v[32:35], v3 offset:5120
    ds_read_b128 v[36:39], v3 offset:6144
    ds_read_b128 v[40:43], v3 offset:7168
    ds_read_b128 v[44:47], v3 offset:8192
    ds_read_b128 v[48:51], v3 offset:9216
    ds_read_b128 v[52:55], v3 offset:10240
    ds_read_b128 v[56:59], v3 offset:11264
    s_waitcnt lgkmcnt(11)
    buffer_store_dwordx4 v[12:15], v4, s[24:27], s34 offen offset:0 sc1
    ds_read_b128 v[60:63], v3 offset:12288
    s_waitcnt lgkmcnt(11)
    buffer_store_dwordx4 v[16:19], v4, s[24:27], s34 offen offset:1024 sc1
    ds_read_b128 v[64:67], v3 offset:13312
    s_waitcnt lgkmcnt(11)
    buffer_store_dwordx4 v[20:23], v4, s[24:27], s34 offen offset:2048 sc1
    ds_read_b128 v[68:71], v3 offset:14336
    s_waitcnt lgkmcnt(11)
    buffer_store_dwordx4 v[24:27], v4, s[24:27], s34 offen offset:3072 sc1
    ds_read_b128 v[72:75], v3 offset:15360
    s_add_u32 s34, s34, 4096
    s_waitcnt lgkmcnt(11)
    buffer_store_dwordx4 v[28:31], v4, s[24:27], s34 offen offset:0 sc1
    ds_read_b128 v[76:79], v3 offset:16384
    s_waitcnt lgkmcnt(11)
    buffer_store_dwordx4 v[32:35], v4, s[24:27], s34 offen offset:1024 sc1
    ds_read_b128 v[80:83], v3 offset:17408
    s_waitcnt lgkmcnt(11)
    buffer_store_dwordx4 v[36:39], v4, s[24:27], s34 offen offset:2048 sc1
    ds_read_b128 v[84:87], v3 offset:18432
    s_waitcnt lgkmcnt(11)
    buffer_store_dwordx4 v[40:43], v4, s[24:27], s34 offen offset:3072 sc1
    ds_read_b128 v[88:91], v3 offset:19456
    s_add_u32 s34, s34, 4096
    s_waitcnt lgkmcnt(11)
    buffer_store_dwordx4 v[44:47], v4, s[24:27], s34 offen offset:0 sc1
    ds_read_b128 v[92:95], v3 offset:20480
    s_waitcnt lgkmcnt(11)
    buffer_store_dwordx4 v[48:51], v4, s[24:27], s34 offen offset:1024 sc1
    ds_read_b128 v[96:99], v3 offset:21504
    s_waitcnt lgkmcnt(11)
    buffer_store_dwordx4 v[52:55], v4, s[24:27], s34 offen offset:2048 sc1
    ds_read_b128 v[100:103], v3 offset:22528
    s_waitcnt lgkmcnt(11)
    buffer_store_dwordx4 v[56:59], v4, s[24:27], s34 offen offset:3072 sc1
    ds_read_b128 v[104:107], v3 offset:23552
    s_add_u32 s34, s34, 4096
    s_waitcnt lgkmcnt(11)
    buffer_store_dwordx4 v[60:63], v4, s[24:27], s34 offen offset:0 sc1
    ds_read_b128 v[108:111], v3 offset:24576
    s_waitcnt lgkmcnt(11)
    buffer_store_dwordx4 v[64:67], v4, s[24:27], s34 offen offset:1024 sc1
    ds_read_b128 v[112:115], v3 offset:25600
    s_waitcnt lgkmcnt(11)
    buffer_store_dwordx4 v[68:71], v4, s[24:27], s34 offen offset:2048 sc1
    ds_read_b128 v[116:119], v3 offset:26624
    s_waitcnt lgkmcnt(11)
    buffer_store_dwordx4 v[72:75], v4, s[24:27], s34 offen offset:3072 sc1
    ds_read_b128 v[120:123], v3 offset:27648
    s_add_u32 s34, s34, 4096
    s_waitcnt lgkmcnt(11)
    buffer_store_dwordx4 v[76:79], v4, s[24:27], s34 offen offset:0 sc1
    ds_read_b128 v[124:127], v3 offset:28672
    s_waitcnt lgkmcnt(11)
    buffer_store_dwordx4 v[80:83], v4, s[24:27], s34 offen offset:1024 sc1
    ds_read_b128 v[128:131], v3 offset:29696
    s_waitcnt lgkmcnt(11)
    buffer_store_dwordx4 v[84:87], v4, s[24:27], s34 offen offset:2048 sc1
    ds_read_b128 v[132:135], v3 offset:30720
    s_waitcnt lgkmcnt(11)
    buffer_store_dwordx4 v[88:91], v4, s[24:27], s34 offen offset:3072 sc1
    ds_read_b128 v[136:139], v3 offset:31744
    s_add_u32 s34, s34, 4096
    s_waitcnt lgkmcnt(11)
    buffer_store_dwordx4 v[92:95], v4, s[24:27], s34 offen offset:0 sc1
    s_waitcnt lgkmcnt(10)
    buffer_store_dwordx4 v[96:99], v4, s[24:27], s34 offen offset:1024 sc1
    s_waitcnt lgkmcnt(9)
    buffer_store_dwordx4 v[100:103], v4, s[24:27], s34 offen offset:2048 sc1
    s_waitcnt lgkmcnt(8)
    buffer_store_dwordx4 v[104:107], v4, s[24:27], s34 offen offset:3072 sc1
    s_add_u32 s34, s34, 4096
    s_waitcnt lgkmcnt(7)
    buffer_store_dwordx4 v[108:111], v4, s[24:27], s34 offen offset:0 sc1
    s_waitcnt lgkmcnt(6)
    buffer_store_dwordx4 v[112:115], v4, s[24:27], s34 offen offset:1024 sc1
    s_waitcnt lgkmcnt(5)
    buffer_store_dwordx4 v[116:119], v4, s[24:27], s34 offen offset:2048 sc1
    s_waitcnt lgkmcnt(4)
    buffer_store_dwordx4 v[120:123], v4, s[24:27], s34 offen offset:3072 sc1
    s_add_u32 s34, s34, 4096
    s_waitcnt lgkmcnt(3)
    buffer_store_dwordx4 v[124:127], v4, s[24:27], s34 offen offset:0 sc1
    s_waitcnt lgkmcnt(2)
    buffer_store_dwordx4 v[128:131], v4, s[24:27], s34 offen offset:1024 sc1
    s_waitcnt lgkmcnt(1)
    buffer_store_dwordx4 v[132:135], v4, s[24:27], s34 offen offset:2048 sc1
    s_waitcnt lgkmcnt(0)
    buffer_store_dwordx4 v[136:139], v4, s[24:27], s34 offen offset:3072 sc1
    s_waitcnt vmcnt(16)
    v_mov_b32 v8, s42
    v_mov_b32 v9, s43
    v_mov_b32 v10, s38
    s_mov_b64 exec, 1
    global_store_dwordx2 v10, v[8:9], s[44:45] offset:0 sc1
    s_mov_b64 exec, -1
    s_waitcnt vmcnt(0)
    v_mov_b32 v8, s42
    v_mov_b32 v9, s43
    v_mov_b32 v10, s38
    s_mov_b64 exec, 1
    global_store_dwordx2 v10, v[8:9], s[44:45] offset:8 sc1
    s_mov_b64 exec, -1
    s_branch concat_heads__softmax_full_mha__mha_block__prompt_kernel_kvjoin
concat_heads__softmax_full_mha__mha_block__prompt_kernel_fetch:
    s_add_u32 s22, s21, 1
    s_and_b32 s22, s22, 7
    s_lshl_b32 s34, s22, 15
    s_lshl_b32 s23, s33, 18
    s_add_u32 s34, s34, s23
    s_lshl_b32 s23, s33, 3
    s_add_u32 s22, s22, s23
    s_lshl_b32 s22, s22, 7
    v_mov_b32 v6, s22
    s_mul_i32 s35, s33, 98304
    s_barrier
    s_mov_b32 s46, 524288
concat_heads__softmax_full_mha__mha_block__prompt_kernel_f1a:
    global_load_dwordx2 v[8:9], v6, s[44:45] offset:0 sc1
    s_waitcnt vmcnt(0)
    v_cmp_ne_u64 vcc, s[42:43], v[8:9]
    s_sub_u32 s46, s46, 1
    s_cmp_eq_u32 s46, 0
    s_cbranch_scc1 concat_heads__softmax_full_mha__mha_block__prompt_kernel_f1a_x
    s_nop 1
    s_cbranch_vccnz concat_heads__softmax_full_mha__mha_block__prompt_kernel_f1a
concat_heads__softmax_full_mha__mha_block__prompt_kernel_f1a_x:
    s_add_u32 m0, s35, 0
    s_add_u32 s22, s34, 0
    buffer_load_dwordx4 v4, s[24:27], s22 offen offset:0 sc1 lds
    buffer_load_dwordx4 v4, s[24:27], s22 offen offset:1024 sc1 lds
    buffer_load_dwordx4 v4, s[24:27], s22 offen offset:2048 sc1 lds
    buffer_load_dwordx4 v4, s[24:27], s22 offen offset:3072 sc1 lds
    s_add_u32 m0, s35, 4096
    s_add_u32 s22, s34, 4096
    buffer_load_dwordx4 v4, s[24:27], s22 offen offset:0 sc1 lds
    buffer_load_dwordx4 v4, s[24:27], s22 offen offset:1024 sc1 lds
    buffer_load_dwordx4 v4, s[24:27], s22 offen offset:2048 sc1 lds
    buffer_load_dwordx4 v4, s[24:27], s22 offen offset:3072 sc1 lds
    s_add_u32 m0, s35, 8192
    s_add_u32 s22, s34, 8192
    buffer_load_dwordx4 v4, s[24:27], s22 offen offset:0 sc1 lds
    buffer_load_dwordx4 v4, s[24:27], s22 offen offset:1024 sc1 lds
    buffer_load_dwordx4 v4, s[24:27], s22 offen offset:2048 sc1 lds
    buffer_load_dwordx4 v4, s[24:27], s22 offen offset:3072 sc1 lds
    s_add_u32 m0, s35, 12288
    s_add_u32 s22, s34, 12288
    buffer_load_dwordx4 v4, s[24:27], s22 offen offset:0 sc1 lds
    buffer_load_dwordx4 v4, s[24:27], s22 offen offset:1024 sc1 lds
    buffer_load_dwordx4 v4, s[24:27], s22 offen offset:2048 sc1 lds
    buffer_load_dwordx4 v4, s[24:27], s22 offen offset:3072 sc1 lds
    global_load_dwordx2 v[8:9], v6, s[44:45] offset:8 sc1
    s_waitcnt vmcnt(0)
    v_cmp_ne_u64 vcc, s[42:43], v[8:9]
    s_nop 4
    s_cbranch_vccnz concat_heads__softmax_full_mha__mha_block__prompt_kernel_late3
    s_add_u32 m0, s35, 16384
    s_add_u32 s22, s34, 16384
    buffer_load_dwordx4 v4, s[24:27], s22 offen offset:0 sc1 lds
    buffer_load_dwordx4 v4, s[24:27], s22 offen offset:1024 sc1 lds
    buffer_load_dwordx4 v4, s[24:27], s22 offen offset:2048 sc1 lds
    buffer_load_dwordx4 v4, s[24:27], s22 offen offset:3072 sc1 lds
    s_add_u32 m0, s35, 20480
    s_add_u32 s22, s34, 20480
    buffer_load_dwordx4 v4, s[24:27], s22 offen offset:0 sc1 lds
    buffer_load_dwordx4 v4, s[24:27], s22 offen offset:1024 sc1 lds
    buffer_load_dwordx4 v4, s[24:27], s22 offen offset:2048 sc1 lds
    buffer_load_dwordx4 v4, s[24:27], s22 offen offset:3072 sc1 lds
    s_add_u32 m0, s35, 24576
    s_add_u32 s22, s34, 24576
    buffer_load_dwordx4 v4, s[24:27], s22 offen offset:0 sc1 lds
    buffer_load_dwordx4 v4, s[24:27], s22 offen offset:1024 sc1 lds
    buffer_load_dwordx4 v4, s[24:27], s22 offen offset:2048 sc1 lds
    buffer_load_dwordx4 v4, s[24:27], s22 offen offset:3072 sc1 lds
    s_add_u32 m0, s35, 28672
    s_add_u32 s22, s34, 28672
    buffer_load_dwordx4 v4, s[24:27], s22 offen offset:0 sc1 lds
    buffer_load_dwordx4 v4, s[24:27], s22 offen offset:1024 sc1 lds
    buffer_load_dwordx4 v4, s[24:27], s22 offen offset:2048 sc1 lds
    buffer_load_dwordx4 v4, s[24:27], s22 offen offset:3072 sc1 lds
concat_heads__softmax_full_mha__mha_block__prompt_kernel_kvjoin:
    s_barrier
    s_mov_b32 s46, 524288
concat_heads__softmax_full_mha__mha_block__prompt_kernel_f1all:
    global_load_dwordx2 v[8:9], v5, s[44:45] offset:8 sc1
    s_waitcnt vmcnt(0)
    v_cmp_ne_u64 vcc, s[42:43], v[8:9]
    s_sub_u32 s46, s46, 1
    s_cmp_eq_u32 s46, 0
    s_cbranch_scc1 concat_heads__softmax_full_mha__mha_block__prompt_kernel_f1all_x
    s_nop 1
    s_cbranch_vccnz concat_heads__softmax_full_mha__mha_block__prompt_kernel_f1all
concat_heads__softmax_full_mha__mha_block__prompt_kernel_f1all_x:
    s_branch concat_heads__softmax_full_mha__mha_block__prompt_kernel_kvgo
concat_heads__softmax_full_mha__mha_block__prompt_kernel_late3:
    s_barrier
    s_mov_b32 s46, 524288
concat_heads__softmax_full_mha__mha_block__prompt_kernel_f1b:
    global_load_dwordx2 v[8:9], v6, s[44:45] offset:8 sc1
    s_waitcnt vmcnt(0)
    v_cmp_ne_u64 vcc, s[42:43], v[8:9]
    s_sub_u32 s46, s46, 1
    s_cmp_eq_u32 s46, 0
    s_cbranch_scc1 concat_heads__softmax_full_mha__mha_block__prompt_kernel_f1b_x
    s_nop 1
    s_cbranch_vccnz concat_heads__softmax_full_mha__mha_block__prompt_kernel_f1b
concat_heads__softmax_full_mha__mha_block__prompt_kernel_f1b_x:
    s_add_u32 m0, s35, 16384
    s_add_u32 s22, s34, 16384
    buffer_load_dwordx4 v4, s[24:27], s22 offen offset:0 sc1 lds
    buffer_load_dwordx4 v4, s[24:27], s22 offen offset:1024 sc1 lds
    buffer_load_dwordx4 v4, s[24:27], s22 offen offset:2048 sc1 lds
    buffer_load_dwordx4 v4, s[24:27], s22 offen offset:3072 sc1 lds
    s_add_u32 m0, s35, 20480
    s_add_u32 s22, s34, 20480
    buffer_load_dwordx4 v4, s[24:27], s22 offen offset:0 sc1 lds
    buffer_load_dwordx4 v4, s[24:27], s22 offen offset:1024 sc1 lds
    buffer_load_dwordx4 v4, s[24:27], s22 offen offset:2048 sc1 lds
    buffer_load_dwordx4 v4, s[24:27], s22 offen offset:3072 sc1 lds
    s_add_u32 m0, s35, 24576
    s_add_u32 s22, s34, 24576
    buffer_load_dwordx4 v4, s[24:27], s22 offen offset:0 sc1 lds
    buffer_load_dwordx4 v4, s[24:27], s22 offen offset:1024 sc1 lds
    buffer_load_dwordx4 v4, s[24:27], s22 offen offset:2048 sc1 lds
    buffer_load_dwordx4 v4, s[24:27], s22 offen offset:3072 sc1 lds
    s_add_u32 m0, s35, 28672
    s_add_u32 s22, s34, 28672
    buffer_load_dwordx4 v4, s[24:27], s22 offen offset:0 sc1 lds
    buffer_load_dwordx4 v4, s[24:27], s22 offen offset:1024 sc1 lds
    buffer_load_dwordx4 v4, s[24:27], s22 offen offset:2048 sc1 lds
    buffer_load_dwordx4 v4, s[24:27], s22 offen offset:3072 sc1 lds
    s_mov_b32 s46, 524288
concat_heads__softmax_full_mha__mha_block__prompt_kernel_f1all2:
    global_load_dwordx2 v[8:9], v5, s[44:45] offset:8 sc1
    s_waitcnt vmcnt(0)
    v_cmp_ne_u64 vcc, s[42:43], v[8:9]
    s_sub_u32 s46, s46, 1
    s_cmp_eq_u32 s46, 0
    s_cbranch_scc1 concat_heads__softmax_full_mha__mha_block__prompt_kernel_f1all2_x
    s_nop 1
    s_cbranch_vccnz concat_heads__softmax_full_mha__mha_block__prompt_kernel_f1all2
concat_heads__softmax_full_mha__mha_block__prompt_kernel_f1all2_x:
concat_heads__softmax_full_mha__mha_block__prompt_kernel_kvgo:
    s_add_u32 s32, s32, 49152
    s_mov_b32 s40, 3
    s_branch concat_heads__softmax_full_mha__mha_block__prompt_kernel_l2entry
concat_heads__softmax_full_mha__mha_block__prompt_kernel_l2loop:
    s_waitcnt vmcnt(8)
    s_barrier
concat_heads__softmax_full_mha__mha_block__prompt_kernel_l2entry:
    s_add_u32 s32, s32, 16384
    s_and_b32 s32, s32, 0x3ffff
    s_add_u32 m0, s36, 32768
    s_add_u32 s22, s32, 0
    buffer_load_dwordx4 v2, s[24:27], s22 offen sc1 lds
    s_add_u32 m0, s36, 65536
    s_add_u32 s22, s32, 262144
    buffer_load_dwordx4 v2, s[24:27], s22 offen sc1 lds
    s_add_u32 m0, s36, 36864
    s_add_u32 s22, s32, 4096
    buffer_load_dwordx4 v2, s[24:27], s22 offen sc1 lds
    s_add_u32 m0, s36, 69632
    s_add_u32 s22, s32, 266240
    buffer_load_dwordx4 v2, s[24:27], s22 offen sc1 lds
    s_add_u32 m0, s36, 40960
    s_add_u32 s22, s32, 8192
    buffer_load_dwordx4 v2, s[24:27], s22 offen sc1 lds
    s_add_u32 m0, s36, 73728
    s_add_u32 s22, s32, 270336
    buffer_load_dwordx4 v2, s[24:27], s22 offen sc1 lds
    s_add_u32 m0, s36, 45056
    s_add_u32 s22, s32, 12288
    buffer_load_dwordx4 v2, s[24:27], s22 offen sc1 lds
    s_add_u32 m0, s36, 77824
    s_add_u32 s22, s32, 274432
    buffer_load_dwordx4 v2, s[24:27], s22 offen sc1 lds
    s_waitcnt vmcnt(8)
    s_barrier
    s_add_u32 s32, s32, 16384
    s_and_b32 s32, s32, 0x3ffff
    s_add_u32 m0, s36, 49152
    s_add_u32 s22, s32, 0
    buffer_load_dwordx4 v2, s[24:27], s22 offen sc1 lds
    s_add_u32 m0, s36, 81920
    s_add_u32 s22, s32, 262144
    buffer_load_dwordx4 v2, s[24:27], s22 offen sc1 lds
    s_add_u32 m0, s36, 53248
    s_add_u32 s22, s32, 4096
    buffer_load_dwordx4 v2, s[24:27], s22 offen sc1 lds
    s_add_u32 m0, s36, 86016
    s_add_u32 s22, s32, 266240
    buffer_load_dwordx4 v2, s[24:27], s22 offen sc1 lds
    s_add_u32 m0, s36, 57344
    s_add_u32 s22, s32, 8192
    buffer_load_dwordx4 v2, s[24:27], s22 offen sc1 lds
    s_add_u32 m0, s36, 90112
    s_add_u32 s22, s32, 270336
    buffer_load_dwordx4 v2, s[24:27], s22 offen sc1 lds
    s_add_u32 m0, s36, 61440
    s_add_u32 s22, s32, 12288
    buffer_load_dwordx4 v2, s[24:27], s22 offen sc1 lds
    s_add_u32 m0, s36, 94208
    s_add_u32 s22, s32, 274432
    buffer_load_dwordx4 v2, s[24:27], s22 offen sc1 lds
    s_waitcnt vmcnt(8)
    s_barrier
    s_add_u32 s32, s32, 16384
    s_and_b32 s32, s32, 0x3ffff
    s_add_u32 m0, s36, 0
    s_add_u32 s22, s32, 0
    buffer_load_dwordx4 v2, s[24:27], s22 offen sc1 lds
    s_add_u32 m0, s36, 98304
    s_add_u32 s22, s32, 262144
    buffer_load_dwordx4 v2, s[24:27], s22 offen sc1 lds
    s_add_u32 m0, s36, 4096
    s_add_u32 s22, s32, 4096
    buffer_load_dwordx4 v2, s[24:27], s22 offen sc1 lds
    s_add_u32 m0, s36, 102400
    s_add_u32 s22, s32, 266240
    buffer_load_dwordx4 v2, s[24:27], s22 offen sc1 lds
    s_add_u32 m0, s36, 8192
    s_add_u32 s22, s32, 8192
    buffer_load_dwordx4 v2, s[24:27], s22 offen sc1 lds
    s_add_u32 m0, s36, 106496
    s_add_u32 s22, s32, 270336
    buffer_load_dwordx4 v2, s[24:27], s22 offen sc1 lds
    s_add_u32 m0, s36, 12288
    s_add_u32 s22, s32, 12288
    buffer_load_dwordx4 v2, s[24:27], s22 offen sc1 lds
    s_add_u32 m0, s36, 110592
    s_add_u32 s22, s32, 274432
    buffer_load_dwordx4 v2, s[24:27], s22 offen sc1 lds
    s_waitcnt vmcnt(8)
    s_barrier
    s_add_u32 s32, s32, 16384
    s_and_b32 s32, s32, 0x3ffff
    s_add_u32 m0, s36, 16384
    s_add_u32 s22, s32, 0
    buffer_load_dwordx4 v2, s[24:27], s22 offen sc1 lds
    s_add_u32 m0, s36, 114688
    s_add_u32 s22, s32, 262144
    buffer_load_dwordx4 v2, s[24:27], s22 offen sc1 lds
    s_add_u32 m0, s36, 20480
    s_add_u32 s22, s32, 4096
    buffer_load_dwordx4 v2, s[24:27], s22 offen sc1 lds
    s_add_u32 m0, s36, 118784
    s_add_u32 s22, s32, 266240
    buffer_load_dwordx4 v2, s[24:27], s22 offen sc1 lds
    s_add_u32 m0, s36, 24576
    s_add_u32 s22, s32, 8192
    buffer_load_dwordx4 v2, s[24:27], s22 offen sc1 lds
    s_add_u32 m0, s36, 122880
    s_add_u32 s22, s32, 270336
    buffer_load_dwordx4 v2, s[24:27], s22 offen sc1 lds
    s_add_u32 m0, s36, 28672
    s_add_u32 s22, s32, 12288
    buffer_load_dwordx4 v2, s[24:27], s22 offen sc1 lds
    s_add_u32 m0, s36, 126976
    s_add_u32 s22, s32, 274432
    buffer_load_dwordx4 v2, s[24:27], s22 offen sc1 lds
    s_sub_u32 s40, s40, 1
    s_cmp_lg_u32 s40, 0
    s_cbranch_scc1 concat_heads__softmax_full_mha__mha_block__prompt_kernel_l2loop
    s_waitcnt vmcnt(8)
    s_barrier
    s_waitcnt vmcnt(0)
    s_barrier
    s_and_b32 s22, s20, 7
    s_lshl_b32 s22, s22, 8
    s_sub_u32 s23, 2097152, s22
    s_add_u32 s28, s8, s22
    s_addc_u32 s29, s9, 0
    s_mov_b32 s30, s23
    s_mov_b32 s31, 0x20000
    v_lshrrev_b32 v6, 4, v0
    v_lshlrev_b32 v7, 1, v6
    v_and_b32 v5, 15, v0
    v_xor_b32 v7, v7, v5
    v_lshlrev_b32 v7, 4, v7
    v_lshl_add_u32 v2, v6, 11, v7
    v_xor_b32 v3, 128, v2
    v_add_u32 v3, 8192, v3
    s_lshl_b32 s22, s19, 3
    s_add_u32 s22, s22, s21
    s_lshl_b32 s22, s22, 1
    s_lshr_b32 s23, s20, 3
    s_add_u32 s22, s22, s23
    s_lshl_b32 s37, s22, 11
    s_lshl_b32 s22, s22, 18
    s_add_u32 s22, s22, 25165824
    s_add_u32 s24, s16, s22
    s_addc_u32 s25, s17, 0
    s_mov_b32 s26, 262144
    s_mov_b32 s27, 0x20000
    s_lshl_b32 s22, s39, 7
    s_add_u32 s37, s37, s22
    s_add_u32 s37, s37, 37879808
    s_add_u32 s44, s16, s37
    s_addc_u32 s45, s17, 0
    s_lshr_b32 s38, s20, 3
    s_or_b32 s38, s38, 2
    v_bfe_u32 v6, v0, 2, 2
    v_xor_b32 v6, s38, v6
    v_lshlrev_b32 v6, 9, v6
    v_and_b32 v7, 3, v0
    v_lshl_add_u32 v5, v7, 3, v6
    s_mov_b32 s32, 0
    s_mov_b32 s33, 0
    s_lshl_b32 s22, s39, 2
    s_lshr_b32 s22, 0x0241, s22
    s_and_b32 s22, s22, 15
    s_lshl_b32 s35, s22, 15
    s_mov_b32 s34, s39
    s_mov_b32 s40, 4
    s_mov_b32 s10, 4
    s_mov_b32 s47, 99
    s_cmp_eq_u32 s39, 3
    s_cbranch_scc1 concat_heads__softmax_full_mha__mha_block__prompt_kernel_l3late
    s_lshl_b32 s41, s38, 2
    s_add_u32 s41, s41, s39
    s_mov_b32 s47, s41
    s_and_b32 s37, s41, 7
    s_lshl_b32 s37, s37, 18
    s_lshr_b32 s22, s41, 3
    s_lshl_b32 s22, s22, 16
    s_add_u32 s37, s37, s22
    s_add_u32 m0, s35, 16384
    s_add_u32 s22, s37, 0
    buffer_load_dwordx4 v2, s[28:31], s22 offen lds
    s_add_u32 m0, s35, 17408
    s_add_u32 s22, s37, 0
    buffer_load_dwordx4 v3, s[28:31], s22 offen lds
    s_add_u32 m0, s35, 18432
    s_add_u32 s22, s37, 16384
    buffer_load_dwordx4 v2, s[28:31], s22 offen lds
    s_add_u32 m0, s35, 19456
    s_add_u32 s22, s37, 16384
    buffer_load_dwordx4 v3, s[28:31], s22 offen lds
    s_add_u32 m0, s35, 20480
    s_add_u32 s22, s37, 32768
    buffer_load_dwordx4 v2, s[28:31], s22 offen lds
    s_add_u32 m0, s35, 21504
    s_add_u32 s22, s37, 32768
    buffer_load_dwordx4 v3, s[28:31], s22 offen lds
    s_add_u32 m0, s35, 22528
    s_add_u32 s22, s37, 49152
    buffer_load_dwordx4 v2, s[28:31], s22 offen lds
    s_add_u32 m0, s35, 23552
    s_add_u32 s22, s37, 49152
    buffer_load_dwordx4 v3, s[28:31], s22 offen lds
    s_add_u32 m0, s35, 24576
    s_add_u32 s22, s37, 131072
    buffer_load_dwordx4 v2, s[28:31], s22 offen lds
    s_add_u32 m0, s35, 25600
    s_add_u32 s22, s37, 131072
    buffer_load_dwordx4 v3, s[28:31], s22 offen lds
    s_add_u32 m0, s35, 26624
    s_add_u32 s22, s37, 147456
    buffer_load_dwordx4 v2, s[28:31], s22 offen lds
    s_add_u32 m0, s35, 27648
    s_add_u32 s22, s37, 147456
    buffer_load_dwordx4 v3, s[28:31], s22 offen lds
    s_add_u32 m0, s35, 28672
    s_add_u32 s22, s37, 163840
    buffer_load_dwordx4 v2, s[28:31], s22 offen lds
    s_add_u32 m0, s35, 29696
    s_add_u32 s22, s37, 163840
    buffer_load_dwordx4 v3, s[28:31], s22 offen lds
    s_add_u32 m0, s35, 30720
    s_add_u32 s22, s37, 180224
    buffer_load_dwordx4 v2, s[28:31], s22 offen lds
    s_add_u32 m0, s35, 31744
    s_add_u32 s22, s37, 180224
    buffer_load_dwordx4 v3, s[28:31], s22 offen lds
    s_branch concat_heads__softmax_full_mha__mha_block__prompt_kernel_l3pick
concat_heads__softmax_full_mha__mha_block__prompt_kernel_l3late:
    global_load_dwordx2 v[8:9], v5, s[44:45] sc1
    s_barrier
    s_mov_b32 s34, 1
    s_mov_b32 s10, 0
    s_waitcnt vmcnt(0)
    v_cmp_eq_u64 vcc, s[42:43], v[8:9]
    s_nop 4
    s_lshr_b32 s22, vcc_lo, 1
    s_and_b32 s22, s22, vcc_lo
    s_lshr_b32 s23, s22, 2
    s_and_b32 s22, s22, s23
    s_and_b32 s32, s22, 0x1111
concat_heads__softmax_full_mha__mha_block__prompt_kernel_l3pick:
    s_mov_b32 s46, 524288
concat_heads__softmax_full_mha__mha_block__prompt_kernel_l3poll:
    s_andn2_b32 s22, s32, s33
    s_cbranch_scc1 concat_heads__softmax_full_mha__mha_block__prompt_kernel_l3go
    global_load_dwordx2 v[8:9], v5, s[44:45] sc1
    s_waitcnt vmcnt(0)
    v_cmp_eq_u64 vcc, s[42:43], v[8:9]
    s_nop 4
    s_lshr_b32 s22, vcc_lo, 1
    s_and_b32 s22, s22, vcc_lo
    s_lshr_b32 s23, s22, 2
    s_and_b32 s22, s22, s23
    s_and_b32 s32, s22, 0x1111
    s_andn2_b32 s22, s32, s33
    s_cbranch_scc1 concat_heads__softmax_full_mha__mha_block__prompt_kernel_l3go
    s_sleep 4
    s_sub_u32 s46, s46, 1
    s_cmp_lg_u32 s46, 0
    s_cbranch_scc1 concat_heads__softmax_full_mha__mha_block__prompt_kernel_l3poll
    s_andn2_b32 s22, 0x1111, s33
concat_heads__softmax_full_mha__mha_block__prompt_kernel_l3go:
    s_ff1_i32_b32 s22, s22
    s_bitset1_b32 s33, s22
    s_lshr_b32 s22, s22, 2
    s_xor_b32 s22, s22, s38
    s_lshl_b32 s22, s22, 2
    s_add_u32 s41, s22, s39
    s_lshl_b32 s36, s41, 12
    s_and_b32 s37, s41, 7
    s_lshl_b32 s37, s37, 18
    s_lshr_b32 s22, s41, 3
    s_lshl_b32 s22, s22, 16
    s_add_u32 s37, s37, s22
    s_add_u32 m0, s35, 0
    s_add_u32 s22, s36, 0
    buffer_load_dwordx4 v4, s[24:27], s22 offen offset:0 sc1 lds
    buffer_load_dwordx4 v4, s[24:27], s22 offen offset:1024 sc1 lds
    buffer_load_dwordx4 v4, s[24:27], s22 offen offset:2048 sc1 lds
    buffer_load_dwordx4 v4, s[24:27], s22 offen offset:3072 sc1 lds
    s_add_u32 m0, s35, 4096
    s_add_u32 s22, s36, 65536
    buffer_load_dwordx4 v4, s[24:27], s22 offen offset:0 sc1 lds
    buffer_load_dwordx4 v4, s[24:27], s22 offen offset:1024 sc1 lds
    buffer_load_dwordx4 v4, s[24:27], s22 offen offset:2048 sc1 lds
    buffer_load_dwordx4 v4, s[24:27], s22 offen offset:3072 sc1 lds
    s_add_u32 m0, s35, 8192
    s_add_u32 s22, s36, 131072
    buffer_load_dwordx4 v4, s[24:27], s22 offen offset:0 sc1 lds
    buffer_load_dwordx4 v4, s[24:27], s22 offen offset:1024 sc1 lds
    buffer_load_dwordx4 v4, s[24:27], s22 offen offset:2048 sc1 lds
    buffer_load_dwordx4 v4, s[24:27], s22 offen offset:3072 sc1 lds
    s_add_u32 m0, s35, 12288
    s_add_u32 s22, s36, 196608
    s_cmp_eq_u32 s40, s10
    s_cbranch_scc1 concat_heads__softmax_full_mha__mha_block__prompt_kernel_l3nb0
    s_barrier
concat_heads__softmax_full_mha__mha_block__prompt_kernel_l3nb0:
    buffer_load_dwordx4 v4, s[24:27], s22 offen offset:0 sc1 lds
    buffer_load_dwordx4 v4, s[24:27], s22 offen offset:1024 sc1 lds
    buffer_load_dwordx4 v4, s[24:27], s22 offen offset:2048 sc1 lds
    buffer_load_dwordx4 v4, s[24:27], s22 offen offset:3072 sc1 lds
    s_cmp_eq_u32 s41, s47
    s_mov_b32 s47, 99
    s_cbranch_scc1 concat_heads__softmax_full_mha__mha_block__prompt_kernel_l3now
    s_add_u32 m0, s35, 16384
    s_add_u32 s22, s37, 0
    buffer_load_dwordx4 v2, s[28:31], s22 offen lds
    s_add_u32 m0, s35, 17408
    s_add_u32 s22, s37, 0
    buffer_load_dwordx4 v3, s[28:31], s22 offen lds
    s_add_u32 m0, s35, 18432
    s_add_u32 s22, s37, 16384
    buffer_load_dwordx4 v2, s[28:31], s22 offen lds
    s_add_u32 m0, s35, 19456
    s_add_u32 s22, s37, 16384
    buffer_load_dwordx4 v3, s[28:31], s22 offen lds
    s_add_u32 m0, s35, 20480
    s_add_u32 s22, s37, 32768
    buffer_load_dwordx4 v2, s[28:31], s22 offen lds
    s_add_u32 m0, s35, 21504
    s_add_u32 s22, s37, 32768
    buffer_load_dwordx4 v3, s[28:31], s22 offen lds
    s_add_u32 m0, s35, 22528
    s_add_u32 s22, s37, 49152
    buffer_load_dwordx4 v2, s[28:31], s22 offen lds
    s_cmp_eq_u32 s40, 4
    s_cbranch_scc1 concat_heads__softmax_full_mha__mha_block__prompt_kernel_l3nb1
    s_barrier
concat_heads__softmax_full_mha__mha_block__prompt_kernel_l3nb1:
    s_add_u32 m0, s35, 23552
    s_add_u32 s22, s37, 49152
    buffer_load_dwordx4 v3, s[28:31], s22 offen lds
    s_add_u32 m0, s35, 24576
    s_add_u32 s22, s37, 131072
    buffer_load_dwordx4 v2, s[28:31], s22 offen lds
    s_add_u32 m0, s35, 25600
    s_add_u32 s22, s37, 131072
    buffer_load_dwordx4 v3, s[28:31], s22 offen lds
    s_add_u32 m0, s35, 26624
    s_add_u32 s22, s37, 147456
    buffer_load_dwordx4 v2, s[28:31], s22 offen lds
    s_add_u32 m0, s35, 27648
    s_add_u32 s22, s37, 147456
    buffer_load_dwordx4 v3, s[28:31], s22 offen lds
    s_add_u32 m0, s35, 28672
    s_add_u32 s22, s37, 163840
    buffer_load_dwordx4 v2, s[28:31], s22 offen lds
    s_add_u32 m0, s35, 29696
    s_add_u32 s22, s37, 163840
    buffer_load_dwordx4 v3, s[28:31], s22 offen lds
    s_add_u32 m0, s35, 30720
    s_add_u32 s22, s37, 180224
    buffer_load_dwordx4 v2, s[28:31], s22 offen lds
    s_add_u32 m0, s35, 31744
    s_add_u32 s22, s37, 180224
    buffer_load_dwordx4 v3, s[28:31], s22 offen lds
concat_heads__softmax_full_mha__mha_block__prompt_kernel_l3now:
concat_heads__softmax_full_mha__mha_block__prompt_kernel_l3skip:
    s_cmp_eq_u32 s34, 0
    s_cbranch_scc1 concat_heads__softmax_full_mha__mha_block__prompt_kernel_l3guard
    s_barrier
    s_sub_u32 s34, s34, 1
    s_branch concat_heads__softmax_full_mha__mha_block__prompt_kernel_l3skip
concat_heads__softmax_full_mha__mha_block__prompt_kernel_l3guard:
    s_andn2_b32 s22, s32, s33
    s_cbranch_scc1 concat_heads__softmax_full_mha__mha_block__prompt_kernel_l3known
    global_load_dwordx2 v[8:9], v5, s[44:45] sc1
    s_waitcnt vmcnt(1)
    s_barrier
    s_waitcnt vmcnt(0)
    v_cmp_eq_u64 vcc, s[42:43], v[8:9]
    s_nop 4
    s_lshr_b32 s22, vcc_lo, 1
    s_and_b32 s22, s22, vcc_lo
    s_lshr_b32 s23, s22, 2
    s_and_b32 s22, s22, s23
    s_and_b32 s32, s22, 0x1111
    s_branch concat_heads__softmax_full_mha__mha_block__prompt_kernel_l3next
concat_heads__softmax_full_mha__mha_block__prompt_kernel_l3known:
    s_waitcnt vmcnt(0)
    s_barrier
concat_heads__softmax_full_mha__mha_block__prompt_kernel_l3next:
    s_sub_u32 s40, s40, 1
    s_cmp_eq_u32 s40, 0
    s_cbranch_scc1 concat_heads__softmax_full_mha__mha_block__prompt_kernel_l3end
    s_mov_b32 s34, 1
    s_add_u32 s35, s35, 65536
    s_sub_u32 s22, s35, 163840
    s_cmp_ge_u32 s35, 163840
    s_cselect_b32 s35, s22, s35
    s_branch concat_heads__softmax_full_mha__mha_block__prompt_kernel_l3pick
concat_heads__softmax_full_mha__mha_block__prompt_kernel_l3end:
concat_heads__softmax_full_mha__mha_block__prompt_kernel_end:
    s_endpgm
.p2align 6
concat_heads__softmax_full_mha__mha_block__prompt_kernel_compute:
    v_lshrrev_b32 v8, 4, v0
    v_bfe_u32 v9, v0, 1, 3
    v_xor_b32 v8, v8, v9
    v_lshlrev_b32 v8, 4, v8
    v_and_b32 v9, 15, v0
    v_lshl_add_u32 v8, v9, 7, v8
    s_and_b32 s22, s18, 3
    s_lshl_b32 s22, s22, 13
    v_add_u32 v2, s22, v8
    v_xor_b32 v3, 64, v2
    v_bfe_u32 v8, v0, 3, 2
    s_lshr_b32 s22, s18, 2
    s_lshl_b32 s22, s22, 1
    v_xor_b32 v8, s22, v8
    v_lshlrev_b32 v8, 5, v8
    v_and_b32 v9, 3, v0
    v_lshl_add_u32 v8, v9, 3, v8
    v_lshrrev_b32 v9, 4, v0
    v_lshl_add_u32 v8, v9, 10, v8
    v_bfe_u32 v9, v0, 2, 2
    v_lshl_add_u32 v8, v9, 7, v8
    v_add_u32 v4, 98304, v8
    v_xor_b32 v5, 32, v4
    s_lshl_b32 s22, s18, 13
    s_add_u32 s22, s22, 32768
    v_lshrrev_b32 v8, 4, v0
    v_lshlrev_b32 v8, 9, v8
    v_and_b32 v9, 15, v0
    v_lshl_add_u32 v8, v9, 4, v8
    v_add_u32 v164, s22, v8
    v_bfe_u32 v8, v0, 4, 1
    v_lshlrev_b32 v8, 10, v8
    v_lshrrev_b32 v9, 5, v0
    v_lshl_add_u32 v8, v9, 9, v8
    v_bfe_u32 v9, v0, 2, 2
    v_lshl_add_u32 v8, v9, 7, v8
    v_and_b32 v9, 3, v0
    v_lshl_add_u32 v8, v9, 4, v8
    v_add_u32 v165, s22, v8
    v_lshlrev_b32 v8, 4, v0
    v_add_u32 v163, s22, v8
    v_lshrrev_b32 v1, 4, v0
    v_mul_u32_u24 v1, 6144, v1
    v_bfe_u32 v9, v0, 2, 2
    v_lshl_add_u32 v1, v9, 11, v1
    v_and_b32 v9, 3, v0
    v_lshl_add_u32 v1, v9, 7, v1
    v_lshlrev_b32 v7, 7, v0
    s_lshl_b32 s41, s21, 2
    s_and_b32 s22, s20, 3
    s_add_u32 s41, s41, s22
    s_lshl_b32 s41, s41, 3
    s_add_u32 s41, s41, s18
    s_lshr_b32 s35, s41, 3
    s_lshl_b32 s22, s18, 5
    s_add_u32 s35, s35, s22
    s_mul_i32 s35, s35, 24576
    s_lshl_b32 s22, s18, 1
    s_sub_i32 s22, s22, 3
    s_max_i32 s22, s22, 0
    s_sub_u32 s47, 15, s22
    s_cmp_eq_u32 s18, 0
    s_cselect_b32 s47, 99, s47
    s_and_b32 s22, s20, 12
    s_lshl_b32 s22, s22, 7
    s_add_u32 s35, s35, s22
    s_mov_b32 s22, 0
    s_waitcnt lgkmcnt(0)
    s_add_u32 s28, s6, s22
    s_addc_u32 s29, s7, 0
    s_mov_b32 s30, 6291456
    s_mov_b32 s31, 0x20000
    s_lshl_b32 s22, s19, 3
    s_add_u32 s22, s22, s21
    s_lshl_b32 s22, s22, 2
    s_and_b32 s23, s18, 3
    s_add_u32 s22, s22, s23
    s_lshr_b32 s88, s22, 1
    s_lshl_b32 s88, s88, 11
    s_lshl_b32 s22, s22, 6
    s_lshl_b32 s89, s20, 1
    s_lshr_b32 s23, s18, 2
    s_add_u32 s89, s89, s23
    s_lshl_b32 s23, s23, 4
    s_add_u32 s23, s23, s20
    s_add_u32 s22, s22, s23
    s_lshl_b32 s22, s22, 11
    s_add_u32 s22, s22, 25165824
    s_add_u32 s80, s16, s22
    s_addc_u32 s81, s17, 0
    s_mov_b32 s82, 67584
    s_mov_b32 s83, 0x20000
    s_lshr_b32 s22, s23, 1
    s_lshl_b32 s22, s22, 7
    s_add_u32 s88, s88, s22
    s_and_b32 s22, s18, 1
    s_lshl_b32 s22, s22, 4
    s_add_u32 s88, s88, s22
    s_and_b32 s22, s20, 1
    s_lshl_b32 s22, s22, 3
    s_add_u32 s88, s88, s22
    s_add_u32 s44, s16, 37879808
    s_addc_u32 s45, s17, 0
    s_mov_b32 s90, 65536
    s_mov_b32 s91, 0
    s_lshl_b32 s22, s21, 2
    s_lshr_b32 s23, s20, 3
    s_lshl_b32 s23, s23, 1
    s_add_u32 s22, s22, s23
    s_and_b32 s23, s18, 1
    s_add_u32 s22, s22, s23
    s_lshl_b32 s22, s22, 18
    s_lshl_b32 s23, s19, 11
    s_add_u32 s22, s22, s23
    s_and_b32 s23, s20, 7
    s_lshl_b32 s23, s23, 8
    s_add_u32 s22, s22, s23
    s_bfe_u32 s23, s18, 0x10001
    s_lshl_b32 s23, s23, 7
    s_add_u32 s22, s22, s23
    s_sub_u32 s23, 8388608, s22
    s_add_u32 s84, s12, s22
    s_addc_u32 s85, s13, 0
    s_mov_b32 s86, s23
    s_mov_b32 s87, 0x20000
    s_lshl_b32 s39, s41, 13
    s_and_b32 s23, s20, 4
    s_lshl_b32 s23, s23, 8
    s_add_u32 s39, s39, s23
    s_mov_b32 s23, 0
    s_add_u32 s24, s8, s23
    s_addc_u32 s25, s9, 0
    s_mov_b32 s26, 2097152
    s_mov_b32 s27, 0x20000
    s_lshl_b32 s22, s2, 3
    s_add_u32 s22, s22, s18
    s_cmp_lg_u32 s22, 0
    s_cbranch_scc1 concat_heads__softmax_full_mha__mha_block__prompt_kernel_nonw
    s_memrealtime s[42:43]
    s_waitcnt lgkmcnt(0)
    s_lshl_b64 s[42:43], s[42:43], 5
    s_or_b32 s42, s42, 16
    v_mov_b32 v8, s42
    v_mov_b32 v9, s43
    v_mov_b32 v10, 0
    s_mov_b64 exec, 1
    global_store_dwordx2 v10, v[8:9], s[14:15] sc1
    s_mov_b64 exec, -1
concat_heads__softmax_full_mha__mha_block__prompt_kernel_nonw:
    v_mov_b64 v[64:65], 0
    v_mov_b64 v[66:67], 0
    v_mov_b64 v[68:69], 0
    v_mov_b64 v[70:71], 0
    v_mov_b64 v[72:73], 0
    v_mov_b64 v[74:75], 0
    v_mov_b64 v[76:77], 0
    v_mov_b64 v[78:79], 0
    v_mov_b64 v[80:81], 0
    v_mov_b64 v[82:83], 0
    v_mov_b64 v[84:85], 0
    v_mov_b64 v[86:87], 0
    v_mov_b64 v[88:89], 0
    v_mov_b64 v[90:91], 0
    v_mov_b64 v[92:93], 0
    v_mov_b64 v[94:95], 0
    v_mov_b64 v[96:97], 0
    v_mov_b64 v[98:99], 0
    v_mov_b64 v[100:101], 0
    v_mov_b64 v[102:103], 0
    v_mov_b64 v[104:105], 0
    v_mov_b64 v[106:107], 0
    v_mov_b64 v[108:109], 0
    v_mov_b64 v[110:111], 0
    v_mov_b64 v[112:113], 0
    v_mov_b64 v[114:115], 0
    v_mov_b64 v[116:117], 0
    v_mov_b64 v[118:119], 0
    v_mov_b64 v[120:121], 0
    v_mov_b64 v[122:123], 0
    v_mov_b64 v[124:125], 0
    v_mov_b64 v[126:127], 0
    v_mov_b64 v[128:129], 0
    v_mov_b64 v[130:131], 0
    v_mov_b64 v[132:133], 0
    v_mov_b64 v[134:135], 0
    v_mov_b64 v[136:137], 0
    v_mov_b64 v[138:139], 0
    v_mov_b64 v[140:141], 0
    v_mov_b64 v[142:143], 0
    v_mov_b64 v[144:145], 0
    v_mov_b64 v[146:147], 0
    v_mov_b64 v[148:149], 0
    v_mov_b64 v[150:151], 0
    v_mov_b64 v[152:153], 0
    v_mov_b64 v[154:155], 0
    v_mov_b64 v[156:157], 0
    v_mov_b64 v[158:159], 0
    s_mov_b32 s32, 0
    s_mov_b32 s33, 0
    s_mov_b32 s34, 12288
    s_mov_b32 s36, 32768
    s_barrier
    ds_read_b64_tr_b16 v[40:41], v4 offset:4096
    ds_read_b64_tr_b16 v[42:43], v4 offset:4608
    ds_read_b128 v[8:11], v2 offset:0
    ds_read_b128 v[12:15], v2 offset:2048
    ds_read_b64_tr_b16 v[44:45], v5 offset:4096
    ds_read_b64_tr_b16 v[46:47], v5 offset:4608
    ds_read_b128 v[16:19], v2 offset:4096
    ds_read_b128 v[20:23], v2 offset:6144
    ds_read_b64_tr_b16 v[48:49], v4 offset:8192
    ds_read_b64_tr_b16 v[50:51], v4 offset:8704
    ds_read_b64_tr_b16 v[52:53], v5 offset:8192
    ds_read_b64_tr_b16 v[54:55], v5 offset:8704
    ds_read_b64_tr_b16 v[56:57], v4 offset:0
    ds_read_b64_tr_b16 v[58:59], v4 offset:512
    s_add_u32 s33, s33, 12288
    s_cmp_ge_u32 s33, 61440
    s_cselect_b32 s38, 4294918144, s34
    s_cselect_b32 s33, 0, s33
    s_waitcnt lgkmcnt(11)
    v_mfma_f32_16x16x32_bf16 v[64:67], v[40:43], v[8:11], v[64:67]
    ds_read_b64_tr_b16 v[60:61], v5 offset:0
    s_waitcnt lgkmcnt(11)
    v_mfma_f32_16x16x32_bf16 v[68:71], v[40:43], v[12:15], v[68:71]
    ds_read_b64_tr_b16 v[62:63], v5 offset:512
    s_waitcnt lgkmcnt(9)
    v_mfma_f32_16x16x32_bf16 v[72:75], v[40:43], v[16:19], v[72:75]
    v_add_u32 v4, s38, v4
    s_waitcnt lgkmcnt(8)
    v_mfma_f32_16x16x32_bf16 v[76:79], v[40:43], v[20:23], v[76:79]
    v_add_u32 v5, s38, v5
    v_mfma_f32_16x16x32_bf16 v[80:83], v[44:47], v[8:11], v[80:83]
    ds_read_b64_tr_b16 v[40:41], v4 offset:4096
    v_mfma_f32_16x16x32_bf16 v[84:87], v[44:47], v[12:15], v[84:87]
    ds_read_b64_tr_b16 v[42:43], v4 offset:4608
    v_mfma_f32_16x16x32_bf16 v[88:91], v[44:47], v[16:19], v[88:91]
    ds_read_b128 v[24:27], v3 offset:0
    v_mfma_f32_16x16x32_bf16 v[92:95], v[44:47], v[20:23], v[92:95]
    ds_read_b128 v[28:31], v3 offset:2048
    s_waitcnt lgkmcnt(10)
    v_mfma_f32_16x16x32_bf16 v[96:99], v[8:11], v[48:51], v[96:99]
    ds_read_b64_tr_b16 v[44:45], v5 offset:4096
    v_mfma_f32_16x16x32_bf16 v[100:103], v[12:15], v[48:51], v[100:103]
    ds_read_b64_tr_b16 v[46:47], v5 offset:4608
    v_mfma_f32_16x16x32_bf16 v[104:107], v[16:19], v[48:51], v[104:107]
    ds_read_b128 v[32:35], v3 offset:4096
    v_mfma_f32_16x16x32_bf16 v[108:111], v[20:23], v[48:51], v[108:111]
    ds_read_b128 v[36:39], v3 offset:6144
    s_waitcnt lgkmcnt(12)
    v_mfma_f32_16x16x32_bf16 v[112:115], v[8:11], v[52:55], v[112:115]
    ds_read_b64_tr_b16 v[48:49], v4 offset:8192
    v_mfma_f32_16x16x32_bf16 v[116:119], v[12:15], v[52:55], v[116:119]
    ds_read_b64_tr_b16 v[50:51], v4 offset:8704
    v_mfma_f32_16x16x32_bf16 v[120:123], v[16:19], v[52:55], v[120:123]
    s_add_u32 s33, s33, 12288
    s_cmp_ge_u32 s33, 61440
    v_mfma_f32_16x16x32_bf16 v[124:127], v[20:23], v[52:55], v[124:127]
    s_cselect_b32 s38, 4294918144, s34
    s_cselect_b32 s33, 0, s33
    s_waitcnt lgkmcnt(12)
    v_mfma_f32_16x16x32_bf16 v[128:131], v[56:59], v[8:11], v[128:131]
    ds_read_b64_tr_b16 v[52:53], v5 offset:8192
    v_mfma_f32_16x16x32_bf16 v[132:135], v[56:59], v[12:15], v[132:135]
    ds_read_b64_tr_b16 v[54:55], v5 offset:8704
    v_mfma_f32_16x16x32_bf16 v[136:139], v[56:59], v[16:19], v[136:139]
    s_add_u32 s32, s32, 32768
    s_cmp_ge_u32 s32, 98304
    v_mfma_f32_16x16x32_bf16 v[140:143], v[56:59], v[20:23], v[140:143]
    s_cselect_b32 s37, 4294901760, s36
    s_cselect_b32 s32, 0, s32
    s_waitcnt lgkmcnt(12)
    v_mfma_f32_16x16x32_bf16 v[144:147], v[60:63], v[8:11], v[144:147]
    ds_read_b64_tr_b16 v[56:57], v4 offset:0
    v_mfma_f32_16x16x32_bf16 v[148:151], v[60:63], v[12:15], v[148:151]
    ds_read_b64_tr_b16 v[58:59], v4 offset:512
    v_mfma_f32_16x16x32_bf16 v[152:155], v[60:63], v[16:19], v[152:155]
    v_mfma_f32_16x16x32_bf16 v[156:159], v[60:63], v[20:23], v[156:159]
    s_mov_b32 s40, 15
.p2align 6
concat_heads__softmax_full_mha__mha_block__prompt_kernel_g1loop:
    s_waitcnt lgkmcnt(11)
    v_mfma_f32_16x16x32_bf16 v[64:67], v[40:43], v[24:27], v[64:67]
    ds_read_b64_tr_b16 v[60:61], v5 offset:0
    s_waitcnt lgkmcnt(11)
    v_mfma_f32_16x16x32_bf16 v[68:71], v[40:43], v[28:31], v[68:71]
    ds_read_b64_tr_b16 v[62:63], v5 offset:512
    s_waitcnt lgkmcnt(9)
    v_mfma_f32_16x16x32_bf16 v[72:75], v[40:43], v[32:35], v[72:75]
    s_waitcnt lgkmcnt(8)
    s_barrier
    v_add_u32 v4, s38, v4
    v_mfma_f32_16x16x32_bf16 v[76:79], v[40:43], v[36:39], v[76:79]
    v_add_u32 v5, s38, v5
    v_add_u32 v2, s37, v2
    v_mfma_f32_16x16x32_bf16 v[80:83], v[44:47], v[24:27], v[80:83]
    ds_read_b64_tr_b16 v[40:41], v4 offset:4096
    v_mfma_f32_16x16x32_bf16 v[84:87], v[44:47], v[28:31], v[84:87]
    ds_read_b64_tr_b16 v[42:43], v4 offset:4608
    v_mfma_f32_16x16x32_bf16 v[88:91], v[44:47], v[32:35], v[88:91]
    ds_read_b128 v[8:11], v2 offset:0
    v_mfma_f32_16x16x32_bf16 v[92:95], v[44:47], v[36:39], v[92:95]
    ds_read_b128 v[12:15], v2 offset:2048
    s_waitcnt lgkmcnt(10)
    v_mfma_f32_16x16x32_bf16 v[96:99], v[24:27], v[48:51], v[96:99]
    ds_read_b64_tr_b16 v[44:45], v5 offset:4096
    v_mfma_f32_16x16x32_bf16 v[100:103], v[28:31], v[48:51], v[100:103]
    ds_read_b64_tr_b16 v[46:47], v5 offset:4608
    v_mfma_f32_16x16x32_bf16 v[104:107], v[32:35], v[48:51], v[104:107]
    ds_read_b128 v[16:19], v2 offset:4096
    v_mfma_f32_16x16x32_bf16 v[108:111], v[36:39], v[48:51], v[108:111]
    ds_read_b128 v[20:23], v2 offset:6144
    s_waitcnt lgkmcnt(12)
    v_mfma_f32_16x16x32_bf16 v[112:115], v[24:27], v[52:55], v[112:115]
    ds_read_b64_tr_b16 v[48:49], v4 offset:8192
    v_mfma_f32_16x16x32_bf16 v[116:119], v[28:31], v[52:55], v[116:119]
    ds_read_b64_tr_b16 v[50:51], v4 offset:8704
    v_mfma_f32_16x16x32_bf16 v[120:123], v[32:35], v[52:55], v[120:123]
    s_add_u32 s33, s33, 12288
    s_cmp_ge_u32 s33, 61440
    v_mfma_f32_16x16x32_bf16 v[124:127], v[36:39], v[52:55], v[124:127]
    s_cselect_b32 s38, 4294918144, s34
    s_cselect_b32 s33, 0, s33
    s_waitcnt lgkmcnt(12)
    v_mfma_f32_16x16x32_bf16 v[128:131], v[56:59], v[24:27], v[128:131]
    ds_read_b64_tr_b16 v[52:53], v5 offset:8192
    v_mfma_f32_16x16x32_bf16 v[132:135], v[56:59], v[28:31], v[132:135]
    ds_read_b64_tr_b16 v[54:55], v5 offset:8704
    v_mfma_f32_16x16x32_bf16 v[136:139], v[56:59], v[32:35], v[136:139]
    v_mfma_f32_16x16x32_bf16 v[140:143], v[56:59], v[36:39], v[140:143]
    s_waitcnt lgkmcnt(12)
    v_mfma_f32_16x16x32_bf16 v[144:147], v[60:63], v[24:27], v[144:147]
    ds_read_b64_tr_b16 v[56:57], v4 offset:0
    v_mfma_f32_16x16x32_bf16 v[148:151], v[60:63], v[28:31], v[148:151]
    ds_read_b64_tr_b16 v[58:59], v4 offset:512
    v_mfma_f32_16x16x32_bf16 v[152:155], v[60:63], v[32:35], v[152:155]
    v_add_u32 v3, s37, v3
    v_mfma_f32_16x16x32_bf16 v[156:159], v[60:63], v[36:39], v[156:159]
    s_cmp_lg_u32 s40, s47
    s_cbranch_scc1 concat_heads__softmax_full_mha__mha_block__prompt_kernel_nowp
    buffer_load_dword v6, v1, s[28:31], s35 offen
concat_heads__softmax_full_mha__mha_block__prompt_kernel_nowp:
    s_waitcnt lgkmcnt(11)
    v_mfma_f32_16x16x32_bf16 v[64:67], v[40:43], v[8:11], v[64:67]
    ds_read_b64_tr_b16 v[60:61], v5 offset:0
    s_waitcnt lgkmcnt(11)
    v_mfma_f32_16x16x32_bf16 v[68:71], v[40:43], v[12:15], v[68:71]
    ds_read_b64_tr_b16 v[62:63], v5 offset:512
    s_waitcnt lgkmcnt(9)
    v_mfma_f32_16x16x32_bf16 v[72:75], v[40:43], v[16:19], v[72:75]
    v_add_u32 v4, s38, v4
    s_waitcnt lgkmcnt(8)
    v_mfma_f32_16x16x32_bf16 v[76:79], v[40:43], v[20:23], v[76:79]
    v_add_u32 v5, s38, v5
    v_mfma_f32_16x16x32_bf16 v[80:83], v[44:47], v[8:11], v[80:83]
    ds_read_b64_tr_b16 v[40:41], v4 offset:4096
    v_mfma_f32_16x16x32_bf16 v[84:87], v[44:47], v[12:15], v[84:87]
    ds_read_b64_tr_b16 v[42:43], v4 offset:4608
    v_mfma_f32_16x16x32_bf16 v[88:91], v[44:47], v[16:19], v[88:91]
    ds_read_b128 v[24:27], v3 offset:0
    v_mfma_f32_16x16x32_bf16 v[92:95], v[44:47], v[20:23], v[92:95]
    ds_read_b128 v[28:31], v3 offset:2048
    s_waitcnt lgkmcnt(10)
    v_mfma_f32_16x16x32_bf16 v[96:99], v[8:11], v[48:51], v[96:99]
    ds_read_b64_tr_b16 v[44:45], v5 offset:4096
    v_mfma_f32_16x16x32_bf16 v[100:103], v[12:15], v[48:51], v[100:103]
    ds_read_b64_tr_b16 v[46:47], v5 offset:4608
    v_mfma_f32_16x16x32_bf16 v[104:107], v[16:19], v[48:51], v[104:107]
    ds_read_b128 v[32:35], v3 offset:4096
    v_mfma_f32_16x16x32_bf16 v[108:111], v[20:23], v[48:51], v[108:111]
    ds_read_b128 v[36:39], v3 offset:6144
    s_waitcnt lgkmcnt(12)
    v_mfma_f32_16x16x32_bf16 v[112:115], v[8:11], v[52:55], v[112:115]
    ds_read_b64_tr_b16 v[48:49], v4 offset:8192
    v_mfma_f32_16x16x32_bf16 v[116:119], v[12:15], v[52:55], v[116:119]
    ds_read_b64_tr_b16 v[50:51], v4 offset:8704
    v_mfma_f32_16x16x32_bf16 v[120:123], v[16:19], v[52:55], v[120:123]
    s_add_u32 s33, s33, 12288
    s_cmp_ge_u32 s33, 61440
    v_mfma_f32_16x16x32_bf16 v[124:127], v[20:23], v[52:55], v[124:127]
    s_cselect_b32 s38, 4294918144, s34
    s_cselect_b32 s33, 0, s33
    s_waitcnt lgkmcnt(12)
    v_mfma_f32_16x16x32_bf16 v[128:131], v[56:59], v[8:11], v[128:131]
    ds_read_b64_tr_b16 v[52:53], v5 offset:8192
    v_mfma_f32_16x16x32_bf16 v[132:135], v[56:59], v[12:15], v[132:135]
    ds_read_b64_tr_b16 v[54:55], v5 offset:8704
    v_mfma_f32_16x16x32_bf16 v[136:139], v[56:59], v[16:19], v[136:139]
    s_add_u32 s32, s32, 32768
    s_cmp_ge_u32 s32, 98304
    v_mfma_f32_16x16x32_bf16 v[140:143], v[56:59], v[20:23], v[140:143]
    s_cselect_b32 s37, 4294901760, s36
    s_cselect_b32 s32, 0, s32
    s_waitcnt lgkmcnt(12)
    v_mfma_f32_16x16x32_bf16 v[144:147], v[60:63], v[8:11], v[144:147]
    ds_read_b64_tr_b16 v[56:57], v4 offset:0
    v_mfma_f32_16x16x32_bf16 v[148:151], v[60:63], v[12:15], v[148:151]
    ds_read_b64_tr_b16 v[58:59], v4 offset:512
    v_mfma_f32_16x16x32_bf16 v[152:155], v[60:63], v[16:19], v[152:155]
    v_mfma_f32_16x16x32_bf16 v[156:159], v[60:63], v[20:23], v[156:159]
    s_sub_u32 s40, s40, 1
    s_cmp_lg_u32 s40, 0
    s_cbranch_scc1 concat_heads__softmax_full_mha__mha_block__prompt_kernel_g1loop
    s_waitcnt lgkmcnt(11)
    v_mfma_f32_16x16x32_bf16 v[64:67], v[40:43], v[24:27], v[64:67]
    ds_read_b64_tr_b16 v[60:61], v5 offset:0
    s_waitcnt lgkmcnt(11)
    v_mfma_f32_16x16x32_bf16 v[68:71], v[40:43], v[28:31], v[68:71]
    ds_read_b64_tr_b16 v[62:63], v5 offset:512
    s_waitcnt lgkmcnt(9)
    v_mfma_f32_16x16x32_bf16 v[72:75], v[40:43], v[32:35], v[72:75]
    s_waitcnt lgkmcnt(8)
    v_mfma_f32_16x16x32_bf16 v[76:79], v[40:43], v[36:39], v[76:79]
    v_mfma_f32_16x16x32_bf16 v[80:83], v[44:47], v[24:27], v[80:83]
    v_mfma_f32_16x16x32_bf16 v[84:87], v[44:47], v[28:31], v[84:87]
    v_mfma_f32_16x16x32_bf16 v[88:91], v[44:47], v[32:35], v[88:91]
    v_mfma_f32_16x16x32_bf16 v[92:95], v[44:47], v[36:39], v[92:95]
    s_waitcnt lgkmcnt(6)
    v_mfma_f32_16x16x32_bf16 v[96:99], v[24:27], v[48:51], v[96:99]
    v_mfma_f32_16x16x32_bf16 v[100:103], v[28:31], v[48:51], v[100:103]
    v_mfma_f32_16x16x32_bf16 v[104:107], v[32:35], v[48:51], v[104:107]
    v_mfma_f32_16x16x32_bf16 v[108:111], v[36:39], v[48:51], v[108:111]
    s_waitcnt lgkmcnt(4)
    v_mfma_f32_16x16x32_bf16 v[112:115], v[24:27], v[52:55], v[112:115]
    v_cvt_pk_bf16_f32 v8, v64, v65
    v_cvt_pk_bf16_f32 v9, v66, v67
    v_mfma_f32_16x16x32_bf16 v[116:119], v[28:31], v[52:55], v[116:119]
    v_cvt_pk_bf16_f32 v10, v80, v81
    v_cvt_pk_bf16_f32 v11, v82, v83
    ds_write_b128 v165, v[8:11] offset:0
    v_mfma_f32_16x16x32_bf16 v[120:123], v[32:35], v[52:55], v[120:123]
    v_cvt_pk_bf16_f32 v12, v68, v69
    v_cvt_pk_bf16_f32 v13, v70, v71
    v_mfma_f32_16x16x32_bf16 v[124:127], v[36:39], v[52:55], v[124:127]
    v_cvt_pk_bf16_f32 v14, v84, v85
    v_cvt_pk_bf16_f32 v15, v86, v87
    ds_write_b128 v165, v[12:15] offset:64
    s_waitcnt lgkmcnt(4)
    v_mfma_f32_16x16x32_bf16 v[128:131], v[56:59], v[24:27], v[128:131]
    v_cvt_pk_bf16_f32 v16, v72, v73
    v_cvt_pk_bf16_f32 v17, v74, v75
    v_mfma_f32_16x16x32_bf16 v[132:135], v[56:59], v[28:31], v[132:135]
    v_cvt_pk_bf16_f32 v18, v88, v89
    v_cvt_pk_bf16_f32 v19, v90, v91
    ds_write_b128 v165, v[16:19] offset:4096
    v_mfma_f32_16x16x32_bf16 v[136:139], v[56:59], v[32:35], v[136:139]
    v_cvt_pk_bf16_f32 v20, v76, v77
    v_cvt_pk_bf16_f32 v21, v78, v79
    v_mfma_f32_16x16x32_bf16 v[140:143], v[56:59], v[36:39], v[140:143]
    v_cvt_pk_bf16_f32 v22, v92, v93
    v_cvt_pk_bf16_f32 v23, v94, v95
    ds_write_b128 v165, v[20:23] offset:4160
    s_waitcnt lgkmcnt(4)
    v_mfma_f32_16x16x32_bf16 v[144:147], v[60:63], v[24:27], v[144:147]
    v_cvt_pk_bf16_f32 v40, v96, v97
    v_cvt_pk_bf16_f32 v41, v98, v99
    v_mfma_f32_16x16x32_bf16 v[148:151], v[60:63], v[28:31], v[148:151]
    v_cvt_pk_bf16_f32 v42, v100, v101
    v_cvt_pk_bf16_f32 v43, v102, v103
    ds_write_b128 v164, v[40:43] offset:2048
    v_mfma_f32_16x16x32_bf16 v[152:155], v[60:63], v[32:35], v[152:155]
    v_cvt_pk_bf16_f32 v44, v104, v105
    v_cvt_pk_bf16_f32 v45, v106, v107
    v_mfma_f32_16x16x32_bf16 v[156:159], v[60:63], v[36:39], v[156:159]
    v_cvt_pk_bf16_f32 v46, v108, v109
    v_cvt_pk_bf16_f32 v47, v110, v111
    ds_write_b128 v164, v[44:47] offset:6144
    v_cvt_pk_bf16_f32 v48, v112, v113
    v_cvt_pk_bf16_f32 v49, v114, v115
    v_cvt_pk_bf16_f32 v50, v116, v117
    v_cvt_pk_bf16_f32 v51, v118, v119
    ds_write_b128 v164, v[48:51] offset:2304
    v_cvt_pk_bf16_f32 v52, v120, v121
    v_cvt_pk_bf16_f32 v53, v122, v123
    v_cvt_pk_bf16_f32 v54, v124, v125
    v_cvt_pk_bf16_f32 v55, v126, v127
    ds_write_b128 v164, v[52:55] offset:6400
    s_waitcnt lgkmcnt(6)
    v_permlane16_swap_b32 v8, v12
    v_permlane16_swap_b32 v9, v13
    v_permlane16_swap_b32 v10, v14
    v_permlane16_swap_b32 v11, v15
    s_mov_b32 s34, 0x3e8293ee
    s_mov_b32 s35, 0x3e8293ee
    v_pk_mul_f32 v[128:129], v[128:129], s[34:35]
    v_pk_mul_f32 v[144:145], v[144:145], s[34:35]
    v_pk_mul_f32 v[130:131], v[130:131], s[34:35]
    v_pk_mul_f32 v[146:147], v[146:147], s[34:35]
    v_cvt_pk_bf16_f32 v24, v128, v129
    v_cvt_pk_bf16_f32 v25, v130, v131
    v_cvt_pk_bf16_f32 v26, v144, v145
    v_cvt_pk_bf16_f32 v27, v146, v147
    v_pk_mul_f32 v[132:133], v[132:133], s[34:35]
    v_pk_mul_f32 v[148:149], v[148:149], s[34:35]
    v_pk_mul_f32 v[134:135], v[134:135], s[34:35]
    v_pk_mul_f32 v[150:151], v[150:151], s[34:35]
    v_cvt_pk_bf16_f32 v28, v132, v133
    v_cvt_pk_bf16_f32 v29, v134, v135
    v_cvt_pk_bf16_f32 v30, v148, v149
    v_cvt_pk_bf16_f32 v31, v150, v151
    s_lshr_b32 s22, s18, 2
    s_lshl_b32 s22, s22, 15
    v_permlane16_swap_b32 v24, v28
    v_permlane16_swap_b32 v25, v29
    v_permlane16_swap_b32 v26, v30
    v_permlane16_swap_b32 v27, v31
    v_pk_mul_f32 v[136:137], v[136:137], s[34:35]
    v_pk_mul_f32 v[152:153], v[152:153], s[34:35]
    v_pk_mul_f32 v[138:139], v[138:139], s[34:35]
    v_pk_mul_f32 v[154:155], v[154:155], s[34:35]
    v_cvt_pk_bf16_f32 v32, v136, v137
    v_cvt_pk_bf16_f32 v33, v138, v139
    v_cvt_pk_bf16_f32 v34, v152, v153
    v_cvt_pk_bf16_f32 v35, v154, v155
    v_pk_mul_f32 v[140:141], v[140:141], s[34:35]
    v_pk_mul_f32 v[156:157], v[156:157], s[34:35]
    v_pk_mul_f32 v[142:143], v[142:143], s[34:35]
    v_pk_mul_f32 v[158:159], v[158:159], s[34:35]
    v_cvt_pk_bf16_f32 v36, v140, v141
    v_cvt_pk_bf16_f32 v37, v142, v143
    v_cvt_pk_bf16_f32 v38, v156, v157
    v_cvt_pk_bf16_f32 v39, v158, v159
    s_add_u32 s22, s22, 32768
    s_nop 0
    v_permlane16_swap_b32 v32, v36
    v_permlane16_swap_b32 v33, v37
    v_permlane16_swap_b32 v34, v38
    v_permlane16_swap_b32 v35, v39
    s_nop 1
    v_mfma_f32_32x32x16_bf16 v[64:79], v[8:11], v[24:27], 0
    v_mfma_f32_32x32x16_bf16 v[64:79], v[12:15], v[28:31], v[64:79]
    v_mfma_f32_32x32x16_bf16 v[80:95], v[8:11], v[32:35], 0
    v_mfma_f32_32x32x16_bf16 v[80:95], v[12:15], v[36:39], v[80:95]
    s_waitcnt lgkmcnt(0)
    s_barrier
    v_lshlrev_b32 v2, 4, v0
    v_add_u32 v2, s22, v2
    v_xor_b32 v3, 0x8000, v2
    ds_read_b128 v[8:11], v2 offset:0
    ds_read_b128 v[12:15], v2 offset:1024
    ds_read_b128 v[16:19], v2 offset:2048
    v_and_b32 v1, 15, v0
    v_mov_b32 v7, 0x3f803f80
    v_cmp_eq_u32 vcc, 0, v1
    v_cmp_eq_u32 s[32:33], 4, v1
    v_mov_b32 v4, 0xdddd
    v_cndmask_b32 v56, 0, v7, vcc
    v_cndmask_b32 v57, 0, v7, vcc
    v_cndmask_b32 v58, 0, v7, s[32:33]
    v_cndmask_b32 v59, 0, v7, s[32:33]
    v_mov_b64 v[20:21], 0
    v_mov_b64 v[22:23], 0
    v_mov_b64 v[128:129], 0
    v_mov_b64 v[130:131], 0
    v_mov_b64 v[132:133], 0
    v_mov_b64 v[134:135], 0
    v_mov_b64 v[136:137], 0
    v_mov_b64 v[138:139], 0
    v_mov_b64 v[140:141], 0
    v_mov_b64 v[142:143], 0
    v_max3_f32 v1, v64, v65, v66
    v_max3_f32 v1, v1, v67, v68
    v_max3_f32 v1, v1, v69, v70
    v_max3_f32 v1, v1, v71, v72
    v_max3_f32 v1, v1, v73, v74
    v_max3_f32 v1, v1, v75, v76
    v_max3_f32 v1, v1, v77, v78
    v_max_f32 v1, v1, v79
    v_mov_b32 v7, v1
    v_mov_b64 v[60:61], 0
    v_mov_b64 v[62:63], 0
    v_permlane32_swap_b32 v1, v7
    s_nop 1
    v_min_f32 v96, -v1, -v7
    v_min_f32 v97, -v1, -v7
    v_mov_b64 v[98:99], v[96:97]
    v_mov_b64 v[100:101], v[96:97]
    v_mov_b64 v[102:103], v[96:97]
    v_mov_b64 v[104:105], v[96:97]
    v_mov_b64 v[106:107], v[96:97]
    v_mov_b64 v[108:109], v[96:97]
    v_mov_b64 v[110:111], v[96:97]
    s_nop 1
    s_waitcnt lgkmcnt(2)
    v_mfma_f32_32x32x16_bf16 v[64:79], v[8:11], v[24:27], v[96:111]
    s_waitcnt lgkmcnt(1)
    v_mfma_f32_32x32x16_bf16 v[64:79], v[12:15], v[28:31], v[64:79]
    v_max3_f32 v1, v80, v81, v82
    v_max3_f32 v1, v1, v83, v84
    v_max3_f32 v1, v1, v85, v86
    v_max3_f32 v1, v1, v87, v88
    v_max3_f32 v1, v1, v89, v90
    v_max3_f32 v1, v1, v91, v92
    v_max3_f32 v1, v1, v93, v94
    v_max_f32 v1, v1, v95
    v_mov_b32 v7, v1
    v_mov_b64 v[160:161], 0
    v_mov_b64 v[162:163], 0
    v_permlane32_swap_b32 v1, v7
    s_nop 1
    v_min_f32 v112, -v1, -v7
    v_min_f32 v113, -v1, -v7
    v_mov_b64 v[114:115], v[112:113]
    v_mov_b64 v[116:117], v[112:113]
    v_mov_b64 v[118:119], v[112:113]
    v_mov_b64 v[120:121], v[112:113]
    v_mov_b64 v[122:123], v[112:113]
    v_mov_b64 v[124:125], v[112:113]
    v_mov_b64 v[126:127], v[112:113]
    v_mov_b64 v[144:145], 0
    v_mov_b64 v[146:147], 0
    v_mov_b64 v[148:149], 0
    v_mov_b64 v[150:151], 0
    v_mov_b64 v[152:153], 0
    v_mov_b64 v[154:155], 0
    v_mov_b64 v[156:157], 0
    v_mov_b64 v[158:159], 0
    v_mov_b64 v[88:89], 0
    v_mov_b64 v[90:91], 0
    v_mov_b64 v[92:93], 0
    v_mov_b64 v[94:95], 0
    s_nop 1
    s_mov_b32 s40, 8
    s_cmp_ge_u32 s18, 4
    s_cbranch_scc1 concat_heads__softmax_full_mha__mha_block__prompt_kernel_atB
    s_setprio 2
.p2align 6
concat_heads__softmax_full_mha__mha_block__prompt_kernel_atloopa:
    v_exp_f32 v64, v64
    v_smfmac_f32_32x32x32_bf16 v[144:159], v[20:23], v[88:95], v4
    ds_read_b128 v[20:23], v2 offset:3072
    v_exp_f32 v65, v65
    v_exp_f32 v66, v66
    v_exp_f32 v67, v67
    v_smfmac_f32_16x16x64_bf16 v[160:163], v[56:59], v[88:95], v4
    v_exp_f32 v68, v68
    v_mfma_f32_32x32x16_bf16 v[80:95], v[8:11], v[32:35], v[112:127]
    ds_read_b128 v[8:11], v2 offset:4096
    v_exp_f32 v69, v69
    v_exp_f32 v70, v70
    v_exp_f32 v71, v71
    v_mfma_f32_32x32x16_bf16 v[80:95], v[12:15], v[36:39], v[80:95]
    ds_read_b128 v[12:15], v2 offset:5120
    v_exp_f32 v72, v72
    v_exp_f32 v73, v73
    v_exp_f32 v74, v74
    s_waitcnt lgkmcnt(3)
    v_smfmac_f32_32x32x32_bf16 v[128:143], v[16:19], v[64:71], v4
    v_exp_f32 v75, v75
    s_setprio 0
    v_exp_f32 v76, v76
    v_exp_f32 v77, v77
    v_exp_f32 v78, v78
    v_exp_f32 v79, v79
    v_smfmac_f32_16x16x64_bf16 v[60:63], v[56:59], v[64:71], v4
    s_setprio 2
    v_exp_f32 v80, v80
    s_waitcnt lgkmcnt(2)
    v_smfmac_f32_32x32x32_bf16 v[128:143], v[20:23], v[72:79], v4
    v_exp_f32 v81, v81
    v_exp_f32 v82, v82
    v_exp_f32 v83, v83
    v_smfmac_f32_16x16x64_bf16 v[60:63], v[56:59], v[72:79], v4
    v_exp_f32 v84, v84
    s_waitcnt lgkmcnt(1)
    v_mfma_f32_32x32x16_bf16 v[64:79], v[8:11], v[24:27], v[96:111]
    v_exp_f32 v85, v85
    v_exp_f32 v86, v86
    v_exp_f32 v87, v87
    s_waitcnt lgkmcnt(0)
    v_mfma_f32_32x32x16_bf16 v[64:79], v[12:15], v[28:31], v[64:79]
    v_exp_f32 v88, v88
    v_exp_f32 v89, v89
    v_exp_f32 v90, v90
    v_smfmac_f32_32x32x32_bf16 v[144:159], v[16:19], v[80:87], v4
    ds_read_b128 v[16:19], v2 offset:6144
    v_exp_f32 v91, v91
    s_setprio 0
    v_exp_f32 v92, v92
    v_exp_f32 v93, v93
    v_exp_f32 v94, v94
    v_exp_f32 v95, v95
    v_smfmac_f32_16x16x64_bf16 v[160:163], v[56:59], v[80:87], v4
    s_setprio 2
    v_exp_f32 v64, v64
    v_smfmac_f32_32x32x32_bf16 v[144:159], v[20:23], v[88:95], v4
    ds_read_b128 v[20:23], v2 offset:7168
    v_exp_f32 v65, v65
    v_exp_f32 v66, v66
    v_exp_f32 v67, v67
    v_smfmac_f32_16x16x64_bf16 v[160:163], v[56:59], v[88:95], v4
    v_exp_f32 v68, v68
    v_mfma_f32_32x32x16_bf16 v[80:95], v[8:11], v[32:35], v[112:127]
    ds_read_b128 v[8:11], v2 offset:8192
    v_exp_f32 v69, v69
    v_exp_f32 v70, v70
    v_exp_f32 v71, v71
    v_mfma_f32_32x32x16_bf16 v[80:95], v[12:15], v[36:39], v[80:95]
    ds_read_b128 v[12:15], v2 offset:9216
    v_exp_f32 v72, v72
    v_exp_f32 v73, v73
    v_exp_f32 v74, v74
    s_waitcnt lgkmcnt(3)
    v_smfmac_f32_32x32x32_bf16 v[128:143], v[16:19], v[64:71], v4
    v_exp_f32 v75, v75
    s_setprio 0
    v_exp_f32 v76, v76
    v_exp_f32 v77, v77
    v_exp_f32 v78, v78
    v_exp_f32 v79, v79
    v_smfmac_f32_16x16x64_bf16 v[60:63], v[56:59], v[64:71], v4
    s_setprio 2
    v_exp_f32 v80, v80
    s_waitcnt lgkmcnt(2)
    v_smfmac_f32_32x32x32_bf16 v[128:143], v[20:23], v[72:79], v4
    v_exp_f32 v81, v81
    v_exp_f32 v82, v82
    v_exp_f32 v83, v83
    v_smfmac_f32_16x16x64_bf16 v[60:63], v[56:59], v[72:79], v4
    v_exp_f32 v84, v84
    s_waitcnt lgkmcnt(1)
    v_mfma_f32_32x32x16_bf16 v[64:79], v[8:11], v[24:27], v[96:111]
    v_exp_f32 v85, v85
    v_exp_f32 v86, v86
    v_exp_f32 v87, v87
    s_waitcnt lgkmcnt(0)
    v_mfma_f32_32x32x16_bf16 v[64:79], v[12:15], v[28:31], v[64:79]
    v_exp_f32 v88, v88
    v_exp_f32 v89, v89
    v_exp_f32 v90, v90
    v_smfmac_f32_32x32x32_bf16 v[144:159], v[16:19], v[80:87], v4
    ds_read_b128 v[16:19], v2 offset:10240
    v_exp_f32 v91, v91
    s_setprio 0
    v_exp_f32 v92, v92
    v_exp_f32 v93, v93
    v_exp_f32 v94, v94
    v_exp_f32 v95, v95
    v_smfmac_f32_16x16x64_bf16 v[160:163], v[56:59], v[80:87], v4
    s_setprio 2
    v_exp_f32 v64, v64
    v_smfmac_f32_32x32x32_bf16 v[144:159], v[20:23], v[88:95], v4
    ds_read_b128 v[20:23], v2 offset:11264
    v_exp_f32 v65, v65
    v_exp_f32 v66, v66
    v_exp_f32 v67, v67
    v_smfmac_f32_16x16x64_bf16 v[160:163], v[56:59], v[88:95], v4
    v_exp_f32 v68, v68
    v_mfma_f32_32x32x16_bf16 v[80:95], v[8:11], v[32:35], v[112:127]
    ds_read_b128 v[8:11], v2 offset:12288
    v_exp_f32 v69, v69
    v_exp_f32 v70, v70
    v_exp_f32 v71, v71
    v_mfma_f32_32x32x16_bf16 v[80:95], v[12:15], v[36:39], v[80:95]
    ds_read_b128 v[12:15], v2 offset:13312
    v_exp_f32 v72, v72
    v_exp_f32 v73, v73
    v_exp_f32 v74, v74
    s_waitcnt lgkmcnt(3)
    v_smfmac_f32_32x32x32_bf16 v[128:143], v[16:19], v[64:71], v4
    v_exp_f32 v75, v75
    s_setprio 0
    v_exp_f32 v76, v76
    v_exp_f32 v77, v77
    v_exp_f32 v78, v78
    v_exp_f32 v79, v79
    v_smfmac_f32_16x16x64_bf16 v[60:63], v[56:59], v[64:71], v4
    s_setprio 2
    v_exp_f32 v80, v80
    s_waitcnt lgkmcnt(2)
    v_smfmac_f32_32x32x32_bf16 v[128:143], v[20:23], v[72:79], v4
    v_exp_f32 v81, v81
    v_exp_f32 v82, v82
    v_exp_f32 v83, v83
    v_smfmac_f32_16x16x64_bf16 v[60:63], v[56:59], v[72:79], v4
    v_exp_f32 v84, v84
    s_waitcnt lgkmcnt(1)
    v_mfma_f32_32x32x16_bf16 v[64:79], v[8:11], v[24:27], v[96:111]
    v_exp_f32 v85, v85
    v_exp_f32 v86, v86
    v_exp_f32 v87, v87
    s_waitcnt lgkmcnt(0)
    v_mfma_f32_32x32x16_bf16 v[64:79], v[12:15], v[28:31], v[64:79]
    v_exp_f32 v88, v88
    v_exp_f32 v89, v89
    v_exp_f32 v90, v90
    v_smfmac_f32_32x32x32_bf16 v[144:159], v[16:19], v[80:87], v4
    ds_read_b128 v[16:19], v2 offset:14336
    v_exp_f32 v91, v91
    s_setprio 0
    v_exp_f32 v92, v92
    v_exp_f32 v93, v93
    v_exp_f32 v94, v94
    v_exp_f32 v95, v95
    v_smfmac_f32_16x16x64_bf16 v[160:163], v[56:59], v[80:87], v4
    s_setprio 2
    s_cmp_eq_u32 s40, 8
    s_cbranch_scc1 concat_heads__softmax_full_mha__mha_block__prompt_kernel_nobara
    s_barrier
concat_heads__softmax_full_mha__mha_block__prompt_kernel_nobara:
    v_exp_f32 v64, v64
    v_smfmac_f32_32x32x32_bf16 v[144:159], v[20:23], v[88:95], v4
    ds_read_b128 v[20:23], v2 offset:15360
    v_exp_f32 v65, v65
    v_exp_f32 v66, v66
    v_exp_f32 v67, v67
    v_smfmac_f32_16x16x64_bf16 v[160:163], v[56:59], v[88:95], v4
    v_exp_f32 v68, v68
    v_mfma_f32_32x32x16_bf16 v[80:95], v[8:11], v[32:35], v[112:127]
    ds_read_b128 v[8:11], v2 offset:16384
    v_exp_f32 v69, v69
    v_exp_f32 v70, v70
    v_exp_f32 v71, v71
    v_mfma_f32_32x32x16_bf16 v[80:95], v[12:15], v[36:39], v[80:95]
    ds_read_b128 v[12:15], v2 offset:17408
    v_exp_f32 v72, v72
    v_exp_f32 v73, v73
    v_exp_f32 v74, v74
    s_waitcnt lgkmcnt(3)
    v_smfmac_f32_32x32x32_bf16 v[128:143], v[16:19], v[64:71], v4
    v_exp_f32 v75, v75
    s_setprio 0
    v_exp_f32 v76, v76
    v_exp_f32 v77, v77
    v_exp_f32 v78, v78
    v_exp_f32 v79, v79
    v_smfmac_f32_16x16x64_bf16 v[60:63], v[56:59], v[64:71], v4
    s_setprio 2
    v_exp_f32 v80, v80
    s_waitcnt lgkmcnt(2)
    v_smfmac_f32_32x32x32_bf16 v[128:143], v[20:23], v[72:79], v4
    v_exp_f32 v81, v81
    v_exp_f32 v82, v82
    v_exp_f32 v83, v83
    v_smfmac_f32_16x16x64_bf16 v[60:63], v[56:59], v[72:79], v4
    v_exp_f32 v84, v84
    s_waitcnt lgkmcnt(1)
    v_mfma_f32_32x32x16_bf16 v[64:79], v[8:11], v[24:27], v[96:111]
    v_exp_f32 v85, v85
    v_exp_f32 v86, v86
    v_exp_f32 v87, v87
    s_waitcnt lgkmcnt(0)
    v_mfma_f32_32x32x16_bf16 v[64:79], v[12:15], v[28:31], v[64:79]
    v_exp_f32 v88, v88
    v_exp_f32 v89, v89
    v_exp_f32 v90, v90
    v_smfmac_f32_32x32x32_bf16 v[144:159], v[16:19], v[80:87], v4
    ds_read_b128 v[16:19], v2 offset:18432
    v_exp_f32 v91, v91
    s_setprio 0
    v_exp_f32 v92, v92
    v_exp_f32 v93, v93
    v_exp_f32 v94, v94
    v_exp_f32 v95, v95
    v_smfmac_f32_16x16x64_bf16 v[160:163], v[56:59], v[80:87], v4
    s_setprio 2
    v_exp_f32 v64, v64
    v_smfmac_f32_32x32x32_bf16 v[144:159], v[20:23], v[88:95], v4
    ds_read_b128 v[20:23], v2 offset:19456
    v_exp_f32 v65, v65
    v_exp_f32 v66, v66
    v_exp_f32 v67, v67
    v_smfmac_f32_16x16x64_bf16 v[160:163], v[56:59], v[88:95], v4
    v_exp_f32 v68, v68
    v_mfma_f32_32x32x16_bf16 v[80:95], v[8:11], v[32:35], v[112:127]
    ds_read_b128 v[8:11], v2 offset:20480
    v_exp_f32 v69, v69
    v_exp_f32 v70, v70
    v_exp_f32 v71, v71
    v_mfma_f32_32x32x16_bf16 v[80:95], v[12:15], v[36:39], v[80:95]
    ds_read_b128 v[12:15], v2 offset:21504
    v_exp_f32 v72, v72
    v_exp_f32 v73, v73
    v_exp_f32 v74, v74
    s_waitcnt lgkmcnt(3)
    v_smfmac_f32_32x32x32_bf16 v[128:143], v[16:19], v[64:71], v4
    v_exp_f32 v75, v75
    s_setprio 0
    v_exp_f32 v76, v76
    v_exp_f32 v77, v77
    v_exp_f32 v78, v78
    v_exp_f32 v79, v79
    v_smfmac_f32_16x16x64_bf16 v[60:63], v[56:59], v[64:71], v4
    s_setprio 2
    v_exp_f32 v80, v80
    s_waitcnt lgkmcnt(2)
    v_smfmac_f32_32x32x32_bf16 v[128:143], v[20:23], v[72:79], v4
    v_exp_f32 v81, v81
    v_exp_f32 v82, v82
    v_exp_f32 v83, v83
    v_smfmac_f32_16x16x64_bf16 v[60:63], v[56:59], v[72:79], v4
    v_exp_f32 v84, v84
    s_waitcnt lgkmcnt(1)
    v_mfma_f32_32x32x16_bf16 v[64:79], v[8:11], v[24:27], v[96:111]
    v_exp_f32 v85, v85
    v_exp_f32 v86, v86
    v_exp_f32 v87, v87
    s_waitcnt lgkmcnt(0)
    v_mfma_f32_32x32x16_bf16 v[64:79], v[12:15], v[28:31], v[64:79]
    v_exp_f32 v88, v88
    v_exp_f32 v89, v89
    v_exp_f32 v90, v90
    v_smfmac_f32_32x32x32_bf16 v[144:159], v[16:19], v[80:87], v4
    ds_read_b128 v[16:19], v2 offset:22528
    v_exp_f32 v91, v91
    s_setprio 0
    v_exp_f32 v92, v92
    v_exp_f32 v93, v93
    v_exp_f32 v94, v94
    v_exp_f32 v95, v95
    v_smfmac_f32_16x16x64_bf16 v[160:163], v[56:59], v[80:87], v4
    s_setprio 2
    s_cmp_eq_u32 s40, 2
    s_cbranch_scc1 concat_heads__softmax_full_mha__mha_block__prompt_kernel_mida
concat_heads__softmax_full_mha__mha_block__prompt_kernel_midreta:
    v_exp_f32 v64, v64
    v_smfmac_f32_32x32x32_bf16 v[144:159], v[20:23], v[88:95], v4
    ds_read_b128 v[20:23], v2 offset:23552
    v_exp_f32 v65, v65
    v_exp_f32 v66, v66
    v_exp_f32 v67, v67
    v_smfmac_f32_16x16x64_bf16 v[160:163], v[56:59], v[88:95], v4
    v_exp_f32 v68, v68
    v_mfma_f32_32x32x16_bf16 v[80:95], v[8:11], v[32:35], v[112:127]
    ds_read_b128 v[8:11], v2 offset:24576
    v_exp_f32 v69, v69
    v_exp_f32 v70, v70
    v_exp_f32 v71, v71
    v_mfma_f32_32x32x16_bf16 v[80:95], v[12:15], v[36:39], v[80:95]
    ds_read_b128 v[12:15], v2 offset:25600
    v_exp_f32 v72, v72
    v_exp_f32 v73, v73
    v_exp_f32 v74, v74
    s_waitcnt lgkmcnt(3)
    v_smfmac_f32_32x32x32_bf16 v[128:143], v[16:19], v[64:71], v4
    v_exp_f32 v75, v75
    s_setprio 0
    v_exp_f32 v76, v76
    v_exp_f32 v77, v77
    v_exp_f32 v78, v78
    v_exp_f32 v79, v79
    v_smfmac_f32_16x16x64_bf16 v[60:63], v[56:59], v[64:71], v4
    s_setprio 2
    v_exp_f32 v80, v80
    s_waitcnt lgkmcnt(2)
    v_smfmac_f32_32x32x32_bf16 v[128:143], v[20:23], v[72:79], v4
    v_exp_f32 v81, v81
    v_exp_f32 v82, v82
    v_exp_f32 v83, v83
    v_smfmac_f32_16x16x64_bf16 v[60:63], v[56:59], v[72:79], v4
    v_exp_f32 v84, v84
    s_waitcnt lgkmcnt(1)
    v_mfma_f32_32x32x16_bf16 v[64:79], v[8:11], v[24:27], v[96:111]
    v_exp_f32 v85, v85
    v_exp_f32 v86, v86
    v_exp_f32 v87, v87
    s_waitcnt lgkmcnt(0)
    v_mfma_f32_32x32x16_bf16 v[64:79], v[12:15], v[28:31], v[64:79]
    v_exp_f32 v88, v88
    v_exp_f32 v89, v89
    v_exp_f32 v90, v90
    v_smfmac_f32_32x32x32_bf16 v[144:159], v[16:19], v[80:87], v4
    ds_read_b128 v[16:19], v2 offset:26624
    v_exp_f32 v91, v91
    s_setprio 0
    v_exp_f32 v92, v92
    v_exp_f32 v93, v93
    v_exp_f32 v94, v94
    v_exp_f32 v95, v95
    v_smfmac_f32_16x16x64_bf16 v[160:163], v[56:59], v[80:87], v4
    s_setprio 2
    v_exp_f32 v64, v64
    v_smfmac_f32_32x32x32_bf16 v[144:159], v[20:23], v[88:95], v4
    ds_read_b128 v[20:23], v2 offset:27648
    v_exp_f32 v65, v65
    v_exp_f32 v66, v66
    v_exp_f32 v67, v67
    v_smfmac_f32_16x16x64_bf16 v[160:163], v[56:59], v[88:95], v4
    v_exp_f32 v68, v68
    v_mfma_f32_32x32x16_bf16 v[80:95], v[8:11], v[32:35], v[112:127]
    ds_read_b128 v[8:11], v2 offset:28672
    v_exp_f32 v69, v69
    v_exp_f32 v70, v70
    v_exp_f32 v71, v71
    v_mfma_f32_32x32x16_bf16 v[80:95], v[12:15], v[36:39], v[80:95]
    ds_read_b128 v[12:15], v2 offset:29696
    v_exp_f32 v72, v72
    v_exp_f32 v73, v73
    v_exp_f32 v74, v74
    s_waitcnt lgkmcnt(3)
    v_smfmac_f32_32x32x32_bf16 v[128:143], v[16:19], v[64:71], v4
    v_exp_f32 v75, v75
    s_setprio 0
    v_exp_f32 v76, v76
    v_exp_f32 v77, v77
    v_exp_f32 v78, v78
    v_exp_f32 v79, v79
    v_smfmac_f32_16x16x64_bf16 v[60:63], v[56:59], v[64:71], v4
    s_setprio 2
    v_exp_f32 v80, v80
    s_waitcnt lgkmcnt(2)
    v_smfmac_f32_32x32x32_bf16 v[128:143], v[20:23], v[72:79], v4
    v_exp_f32 v81, v81
    v_exp_f32 v82, v82
    v_exp_f32 v83, v83
    v_smfmac_f32_16x16x64_bf16 v[60:63], v[56:59], v[72:79], v4
    v_exp_f32 v84, v84
    s_waitcnt lgkmcnt(1)
    v_mfma_f32_32x32x16_bf16 v[64:79], v[8:11], v[24:27], v[96:111]
    v_exp_f32 v85, v85
    v_exp_f32 v86, v86
    v_exp_f32 v87, v87
    s_waitcnt lgkmcnt(0)
    v_mfma_f32_32x32x16_bf16 v[64:79], v[12:15], v[28:31], v[64:79]
    v_exp_f32 v88, v88
    v_exp_f32 v89, v89
    v_exp_f32 v90, v90
    v_smfmac_f32_32x32x32_bf16 v[144:159], v[16:19], v[80:87], v4
    ds_read_b128 v[16:19], v2 offset:30720
    v_exp_f32 v91, v91
    s_setprio 0
    v_exp_f32 v92, v92
    v_exp_f32 v93, v93
    v_exp_f32 v94, v94
    v_exp_f32 v95, v95
    v_smfmac_f32_16x16x64_bf16 v[160:163], v[56:59], v[80:87], v4
    s_setprio 2
    v_exp_f32 v64, v64
    v_smfmac_f32_32x32x32_bf16 v[144:159], v[20:23], v[88:95], v4
    ds_read_b128 v[20:23], v2 offset:31744
    v_exp_f32 v65, v65
    v_exp_f32 v66, v66
    v_exp_f32 v67, v67
    v_smfmac_f32_16x16x64_bf16 v[160:163], v[56:59], v[88:95], v4
    v_exp_f32 v68, v68
    v_mfma_f32_32x32x16_bf16 v[80:95], v[8:11], v[32:35], v[112:127]
    s_cmp_eq_u32 s40, 1
    s_cbranch_scc1 concat_heads__softmax_full_mha__mha_block__prompt_kernel_nobar7xa
    s_barrier
concat_heads__softmax_full_mha__mha_block__prompt_kernel_nobar7xa:
    ds_read_b128 v[8:11], v3 offset:0
    v_exp_f32 v69, v69
    v_exp_f32 v70, v70
    v_exp_f32 v71, v71
    v_mfma_f32_32x32x16_bf16 v[80:95], v[12:15], v[36:39], v[80:95]
    ds_read_b128 v[12:15], v3 offset:1024
    v_exp_f32 v72, v72
    v_exp_f32 v73, v73
    v_exp_f32 v74, v74
    s_waitcnt lgkmcnt(3)
    v_smfmac_f32_32x32x32_bf16 v[128:143], v[16:19], v[64:71], v4
    v_exp_f32 v75, v75
    s_setprio 0
    v_exp_f32 v76, v76
    v_exp_f32 v77, v77
    v_exp_f32 v78, v78
    v_exp_f32 v79, v79
    v_smfmac_f32_16x16x64_bf16 v[60:63], v[56:59], v[64:71], v4
    s_setprio 2
    v_exp_f32 v80, v80
    s_waitcnt lgkmcnt(2)
    v_smfmac_f32_32x32x32_bf16 v[128:143], v[20:23], v[72:79], v4
    v_exp_f32 v81, v81
    v_exp_f32 v82, v82
    v_exp_f32 v83, v83
    v_smfmac_f32_16x16x64_bf16 v[60:63], v[56:59], v[72:79], v4
    v_exp_f32 v84, v84
    s_waitcnt lgkmcnt(1)
    v_mfma_f32_32x32x16_bf16 v[64:79], v[8:11], v[24:27], v[96:111]
    v_exp_f32 v85, v85
    v_exp_f32 v86, v86
    v_exp_f32 v87, v87
    s_waitcnt lgkmcnt(0)
    v_mfma_f32_32x32x16_bf16 v[64:79], v[12:15], v[28:31], v[64:79]
    v_exp_f32 v88, v88
    v_exp_f32 v89, v89
    v_exp_f32 v90, v90
    v_smfmac_f32_32x32x32_bf16 v[144:159], v[16:19], v[80:87], v4
    ds_read_b128 v[16:19], v3 offset:2048
    v_exp_f32 v91, v91
    s_setprio 0
    v_exp_f32 v92, v92
    v_exp_f32 v93, v93
    v_exp_f32 v94, v94
    v_exp_f32 v95, v95
    v_smfmac_f32_16x16x64_bf16 v[160:163], v[56:59], v[80:87], v4
    s_setprio 2
    v_xor_b32 v2, 0x8000, v2
    v_xor_b32 v3, 0x8000, v3
    s_sub_u32 s40, s40, 1
    s_cmp_lg_u32 s40, 0
    s_cbranch_scc1 concat_heads__softmax_full_mha__mha_block__prompt_kernel_atloopa
    s_branch concat_heads__softmax_full_mha__mha_block__prompt_kernel_atdone
concat_heads__softmax_full_mha__mha_block__prompt_kernel_atB:
    s_setprio 1
.p2align 6
concat_heads__softmax_full_mha__mha_block__prompt_kernel_atloopb:
    v_exp_f32 v64, v64
    v_smfmac_f32_32x32x32_bf16 v[144:159], v[20:23], v[88:95], v4
    ds_read_b128 v[20:23], v2 offset:3072
    v_exp_f32 v65, v65
    v_exp_f32 v66, v66
    v_exp_f32 v67, v67
    v_smfmac_f32_16x16x64_bf16 v[160:163], v[56:59], v[88:95], v4
    v_exp_f32 v68, v68
    v_mfma_f32_32x32x16_bf16 v[80:95], v[8:11], v[32:35], v[112:127]
    ds_read_b128 v[8:11], v2 offset:4096
    v_exp_f32 v69, v69
    v_exp_f32 v70, v70
    v_exp_f32 v71, v71
    v_mfma_f32_32x32x16_bf16 v[80:95], v[12:15], v[36:39], v[80:95]
    ds_read_b128 v[12:15], v2 offset:5120
    v_exp_f32 v72, v72
    v_exp_f32 v73, v73
    v_exp_f32 v74, v74
    s_waitcnt lgkmcnt(3)
    v_smfmac_f32_32x32x32_bf16 v[128:143], v[16:19], v[64:71], v4
    v_exp_f32 v75, v75
    v_exp_f32 v76, v76
    v_exp_f32 v77, v77
    v_exp_f32 v78, v78
    v_exp_f32 v79, v79
    v_smfmac_f32_16x16x64_bf16 v[60:63], v[56:59], v[64:71], v4
    v_exp_f32 v80, v80
    s_waitcnt lgkmcnt(2)
    v_smfmac_f32_32x32x32_bf16 v[128:143], v[20:23], v[72:79], v4
    v_exp_f32 v81, v81
    v_exp_f32 v82, v82
    v_exp_f32 v83, v83
    v_smfmac_f32_16x16x64_bf16 v[60:63], v[56:59], v[72:79], v4
    v_exp_f32 v84, v84
    s_waitcnt lgkmcnt(1)
    v_mfma_f32_32x32x16_bf16 v[64:79], v[8:11], v[24:27], v[96:111]
    v_exp_f32 v85, v85
    v_exp_f32 v86, v86
    v_exp_f32 v87, v87
    s_waitcnt lgkmcnt(0)
    v_mfma_f32_32x32x16_bf16 v[64:79], v[12:15], v[28:31], v[64:79]
    v_exp_f32 v88, v88
    v_exp_f32 v89, v89
    v_exp_f32 v90, v90
    v_smfmac_f32_32x32x32_bf16 v[144:159], v[16:19], v[80:87], v4
    ds_read_b128 v[16:19], v2 offset:6144
    v_exp_f32 v91, v91
    v_exp_f32 v92, v92
    v_exp_f32 v93, v93
    v_exp_f32 v94, v94
    v_exp_f32 v95, v95
    v_smfmac_f32_16x16x64_bf16 v[160:163], v[56:59], v[80:87], v4
    s_nop 0
    v_exp_f32 v64, v64
    v_smfmac_f32_32x32x32_bf16 v[144:159], v[20:23], v[88:95], v4
    ds_read_b128 v[20:23], v2 offset:7168
    v_exp_f32 v65, v65
    v_exp_f32 v66, v66
    v_exp_f32 v67, v67
    v_smfmac_f32_16x16x64_bf16 v[160:163], v[56:59], v[88:95], v4
    v_exp_f32 v68, v68
    v_mfma_f32_32x32x16_bf16 v[80:95], v[8:11], v[32:35], v[112:127]
    ds_read_b128 v[8:11], v2 offset:8192
    v_exp_f32 v69, v69
    v_exp_f32 v70, v70
    v_exp_f32 v71, v71
    v_mfma_f32_32x32x16_bf16 v[80:95], v[12:15], v[36:39], v[80:95]
    ds_read_b128 v[12:15], v2 offset:9216
    v_exp_f32 v72, v72
    v_exp_f32 v73, v73
    v_exp_f32 v74, v74
    s_waitcnt lgkmcnt(3)
    v_smfmac_f32_32x32x32_bf16 v[128:143], v[16:19], v[64:71], v4
    v_exp_f32 v75, v75
    v_exp_f32 v76, v76
    v_exp_f32 v77, v77
    v_exp_f32 v78, v78
    v_exp_f32 v79, v79
    v_smfmac_f32_16x16x64_bf16 v[60:63], v[56:59], v[64:71], v4
    v_exp_f32 v80, v80
    s_waitcnt lgkmcnt(2)
    v_smfmac_f32_32x32x32_bf16 v[128:143], v[20:23], v[72:79], v4
    v_exp_f32 v81, v81
    v_exp_f32 v82, v82
    v_exp_f32 v83, v83
    v_smfmac_f32_16x16x64_bf16 v[60:63], v[56:59], v[72:79], v4
    v_exp_f32 v84, v84
    s_waitcnt lgkmcnt(1)
    v_mfma_f32_32x32x16_bf16 v[64:79], v[8:11], v[24:27], v[96:111]
    v_exp_f32 v85, v85
    v_exp_f32 v86, v86
    v_exp_f32 v87, v87
    s_waitcnt lgkmcnt(0)
    v_mfma_f32_32x32x16_bf16 v[64:79], v[12:15], v[28:31], v[64:79]
    v_exp_f32 v88, v88
    v_exp_f32 v89, v89
    v_exp_f32 v90, v90
    v_smfmac_f32_32x32x32_bf16 v[144:159], v[16:19], v[80:87], v4
    ds_read_b128 v[16:19], v2 offset:10240
    v_exp_f32 v91, v91
    v_exp_f32 v92, v92
    v_exp_f32 v93, v93
    v_exp_f32 v94, v94
    v_exp_f32 v95, v95
    v_smfmac_f32_16x16x64_bf16 v[160:163], v[56:59], v[80:87], v4
    s_nop 0
    v_exp_f32 v64, v64
    v_smfmac_f32_32x32x32_bf16 v[144:159], v[20:23], v[88:95], v4
    ds_read_b128 v[20:23], v2 offset:11264
    v_exp_f32 v65, v65
    v_exp_f32 v66, v66
    v_exp_f32 v67, v67
    v_smfmac_f32_16x16x64_bf16 v[160:163], v[56:59], v[88:95], v4
    v_exp_f32 v68, v68
    v_mfma_f32_32x32x16_bf16 v[80:95], v[8:11], v[32:35], v[112:127]
    ds_read_b128 v[8:11], v2 offset:12288
    v_exp_f32 v69, v69
    v_exp_f32 v70, v70
    v_exp_f32 v71, v71
    v_mfma_f32_32x32x16_bf16 v[80:95], v[12:15], v[36:39], v[80:95]
    ds_read_b128 v[12:15], v2 offset:13312
    v_exp_f32 v72, v72
    v_exp_f32 v73, v73
    v_exp_f32 v74, v74
    s_waitcnt lgkmcnt(3)
    v_smfmac_f32_32x32x32_bf16 v[128:143], v[16:19], v[64:71], v4
    v_exp_f32 v75, v75
    v_exp_f32 v76, v76
    v_exp_f32 v77, v77
    v_exp_f32 v78, v78
    v_exp_f32 v79, v79
    v_smfmac_f32_16x16x64_bf16 v[60:63], v[56:59], v[64:71], v4
    v_exp_f32 v80, v80
    s_waitcnt lgkmcnt(2)
    v_smfmac_f32_32x32x32_bf16 v[128:143], v[20:23], v[72:79], v4
    v_exp_f32 v81, v81
    v_exp_f32 v82, v82
    v_exp_f32 v83, v83
    v_smfmac_f32_16x16x64_bf16 v[60:63], v[56:59], v[72:79], v4
    v_exp_f32 v84, v84
    s_waitcnt lgkmcnt(1)
    v_mfma_f32_32x32x16_bf16 v[64:79], v[8:11], v[24:27], v[96:111]
    v_exp_f32 v85, v85
    v_exp_f32 v86, v86
    v_exp_f32 v87, v87
    s_waitcnt lgkmcnt(0)
    v_mfma_f32_32x32x16_bf16 v[64:79], v[12:15], v[28:31], v[64:79]
    v_exp_f32 v88, v88
    v_exp_f32 v89, v89
    v_exp_f32 v90, v90
    v_smfmac_f32_32x32x32_bf16 v[144:159], v[16:19], v[80:87], v4
    ds_read_b128 v[16:19], v2 offset:14336
    v_exp_f32 v91, v91
    v_exp_f32 v92, v92
    v_exp_f32 v93, v93
    v_exp_f32 v94, v94
    v_exp_f32 v95, v95
    v_smfmac_f32_16x16x64_bf16 v[160:163], v[56:59], v[80:87], v4
    s_cmp_eq_u32 s40, 8
    s_cbranch_scc1 concat_heads__softmax_full_mha__mha_block__prompt_kernel_nobarb
    s_barrier
concat_heads__softmax_full_mha__mha_block__prompt_kernel_nobarb:
    s_cmp_lg_u32 s40, 1
    s_cbranch_scc1 concat_heads__softmax_full_mha__mha_block__prompt_kernel_noendp
    s_setprio 3
concat_heads__softmax_full_mha__mha_block__prompt_kernel_noendp:
    v_exp_f32 v64, v64
    v_smfmac_f32_32x32x32_bf16 v[144:159], v[20:23], v[88:95], v4
    ds_read_b128 v[20:23], v2 offset:15360
    v_exp_f32 v65, v65
    v_exp_f32 v66, v66
    v_exp_f32 v67, v67
    v_smfmac_f32_16x16x64_bf16 v[160:163], v[56:59], v[88:95], v4
    v_exp_f32 v68, v68
    v_mfma_f32_32x32x16_bf16 v[80:95], v[8:11], v[32:35], v[112:127]
    ds_read_b128 v[8:11], v2 offset:16384
    v_exp_f32 v69, v69
    v_exp_f32 v70, v70
    v_exp_f32 v71, v71
    v_mfma_f32_32x32x16_bf16 v[80:95], v[12:15], v[36:39], v[80:95]
    ds_read_b128 v[12:15], v2 offset:17408
    v_exp_f32 v72, v72
    v_exp_f32 v73, v73
    v_exp_f32 v74, v74
    s_waitcnt lgkmcnt(3)
    v_smfmac_f32_32x32x32_bf16 v[128:143], v[16:19], v[64:71], v4
    v_exp_f32 v75, v75
    v_exp_f32 v76, v76
    v_exp_f32 v77, v77
    v_exp_f32 v78, v78
    v_exp_f32 v79, v79
    v_smfmac_f32_16x16x64_bf16 v[60:63], v[56:59], v[64:71], v4
    v_exp_f32 v80, v80
    s_waitcnt lgkmcnt(2)
    v_smfmac_f32_32x32x32_bf16 v[128:143], v[20:23], v[72:79], v4
    v_exp_f32 v81, v81
    v_exp_f32 v82, v82
    v_exp_f32 v83, v83
    v_smfmac_f32_16x16x64_bf16 v[60:63], v[56:59], v[72:79], v4
    v_exp_f32 v84, v84
    s_waitcnt lgkmcnt(1)
    v_mfma_f32_32x32x16_bf16 v[64:79], v[8:11], v[24:27], v[96:111]
    v_exp_f32 v85, v85
    v_exp_f32 v86, v86
    v_exp_f32 v87, v87
    s_waitcnt lgkmcnt(0)
    v_mfma_f32_32x32x16_bf16 v[64:79], v[12:15], v[28:31], v[64:79]
    v_exp_f32 v88, v88
    v_exp_f32 v89, v89
    v_exp_f32 v90, v90
    v_smfmac_f32_32x32x32_bf16 v[144:159], v[16:19], v[80:87], v4
    ds_read_b128 v[16:19], v2 offset:18432
    v_exp_f32 v91, v91
    v_exp_f32 v92, v92
    v_exp_f32 v93, v93
    v_exp_f32 v94, v94
    v_exp_f32 v95, v95
    v_smfmac_f32_16x16x64_bf16 v[160:163], v[56:59], v[80:87], v4
    s_nop 0
    v_exp_f32 v64, v64
    v_smfmac_f32_32x32x32_bf16 v[144:159], v[20:23], v[88:95], v4
    ds_read_b128 v[20:23], v2 offset:19456
    v_exp_f32 v65, v65
    v_exp_f32 v66, v66
    v_exp_f32 v67, v67
    v_smfmac_f32_16x16x64_bf16 v[160:163], v[56:59], v[88:95], v4
    v_exp_f32 v68, v68
    v_mfma_f32_32x32x16_bf16 v[80:95], v[8:11], v[32:35], v[112:127]
    ds_read_b128 v[8:11], v2 offset:20480
    v_exp_f32 v69, v69
    v_exp_f32 v70, v70
    v_exp_f32 v71, v71
    v_mfma_f32_32x32x16_bf16 v[80:95], v[12:15], v[36:39], v[80:95]
    ds_read_b128 v[12:15], v2 offset:21504
    v_exp_f32 v72, v72
    v_exp_f32 v73, v73
    v_exp_f32 v74, v74
    s_waitcnt lgkmcnt(3)
    v_smfmac_f32_32x32x32_bf16 v[128:143], v[16:19], v[64:71], v4
    v_exp_f32 v75, v75
    v_exp_f32 v76, v76
    v_exp_f32 v77, v77
    v_exp_f32 v78, v78
    v_exp_f32 v79, v79
    v_smfmac_f32_16x16x64_bf16 v[60:63], v[56:59], v[64:71], v4
    v_exp_f32 v80, v80
    s_waitcnt lgkmcnt(2)
    v_smfmac_f32_32x32x32_bf16 v[128:143], v[20:23], v[72:79], v4
    v_exp_f32 v81, v81
    v_exp_f32 v82, v82
    v_exp_f32 v83, v83
    v_smfmac_f32_16x16x64_bf16 v[60:63], v[56:59], v[72:79], v4
    v_exp_f32 v84, v84
    s_waitcnt lgkmcnt(1)
    v_mfma_f32_32x32x16_bf16 v[64:79], v[8:11], v[24:27], v[96:111]
    v_exp_f32 v85, v85
    v_exp_f32 v86, v86
    v_exp_f32 v87, v87
    s_waitcnt lgkmcnt(0)
    v_mfma_f32_32x32x16_bf16 v[64:79], v[12:15], v[28:31], v[64:79]
    v_exp_f32 v88, v88
    v_exp_f32 v89, v89
    v_exp_f32 v90, v90
    v_smfmac_f32_32x32x32_bf16 v[144:159], v[16:19], v[80:87], v4
    ds_read_b128 v[16:19], v2 offset:22528
    v_exp_f32 v91, v91
    v_exp_f32 v92, v92
    v_exp_f32 v93, v93
    v_exp_f32 v94, v94
    v_exp_f32 v95, v95
    v_smfmac_f32_16x16x64_bf16 v[160:163], v[56:59], v[80:87], v4
    s_cmp_eq_u32 s40, 2
    s_cbranch_scc1 concat_heads__softmax_full_mha__mha_block__prompt_kernel_midb
concat_heads__softmax_full_mha__mha_block__prompt_kernel_midretb:
    v_exp_f32 v64, v64
    v_smfmac_f32_32x32x32_bf16 v[144:159], v[20:23], v[88:95], v4
    ds_read_b128 v[20:23], v2 offset:23552
    v_exp_f32 v65, v65
    v_exp_f32 v66, v66
    v_exp_f32 v67, v67
    v_smfmac_f32_16x16x64_bf16 v[160:163], v[56:59], v[88:95], v4
    v_exp_f32 v68, v68
    v_mfma_f32_32x32x16_bf16 v[80:95], v[8:11], v[32:35], v[112:127]
    ds_read_b128 v[8:11], v2 offset:24576
    v_exp_f32 v69, v69
    v_exp_f32 v70, v70
    v_exp_f32 v71, v71
    v_mfma_f32_32x32x16_bf16 v[80:95], v[12:15], v[36:39], v[80:95]
    ds_read_b128 v[12:15], v2 offset:25600
    v_exp_f32 v72, v72
    v_exp_f32 v73, v73
    v_exp_f32 v74, v74
    s_waitcnt lgkmcnt(3)
    v_smfmac_f32_32x32x32_bf16 v[128:143], v[16:19], v[64:71], v4
    v_exp_f32 v75, v75
    v_exp_f32 v76, v76
    v_exp_f32 v77, v77
    v_exp_f32 v78, v78
    v_exp_f32 v79, v79
    v_smfmac_f32_16x16x64_bf16 v[60:63], v[56:59], v[64:71], v4
    v_exp_f32 v80, v80
    s_waitcnt lgkmcnt(2)
    v_smfmac_f32_32x32x32_bf16 v[128:143], v[20:23], v[72:79], v4
    v_exp_f32 v81, v81
    v_exp_f32 v82, v82
    v_exp_f32 v83, v83
    v_smfmac_f32_16x16x64_bf16 v[60:63], v[56:59], v[72:79], v4
    v_exp_f32 v84, v84
    s_waitcnt lgkmcnt(1)
    v_mfma_f32_32x32x16_bf16 v[64:79], v[8:11], v[24:27], v[96:111]
    v_exp_f32 v85, v85
    v_exp_f32 v86, v86
    v_exp_f32 v87, v87
    s_waitcnt lgkmcnt(0)
    v_mfma_f32_32x32x16_bf16 v[64:79], v[12:15], v[28:31], v[64:79]
    v_exp_f32 v88, v88
    v_exp_f32 v89, v89
    v_exp_f32 v90, v90
    v_smfmac_f32_32x32x32_bf16 v[144:159], v[16:19], v[80:87], v4
    ds_read_b128 v[16:19], v2 offset:26624
    v_exp_f32 v91, v91
    v_exp_f32 v92, v92
    v_exp_f32 v93, v93
    v_exp_f32 v94, v94
    v_exp_f32 v95, v95
    v_smfmac_f32_16x16x64_bf16 v[160:163], v[56:59], v[80:87], v4
    s_nop 0
    v_exp_f32 v64, v64
    v_smfmac_f32_32x32x32_bf16 v[144:159], v[20:23], v[88:95], v4
    ds_read_b128 v[20:23], v2 offset:27648
    v_exp_f32 v65, v65
    v_exp_f32 v66, v66
    v_exp_f32 v67, v67
    v_smfmac_f32_16x16x64_bf16 v[160:163], v[56:59], v[88:95], v4
    v_exp_f32 v68, v68
    v_mfma_f32_32x32x16_bf16 v[80:95], v[8:11], v[32:35], v[112:127]
    ds_read_b128 v[8:11], v2 offset:28672
    v_exp_f32 v69, v69
    v_exp_f32 v70, v70
    v_exp_f32 v71, v71
    v_mfma_f32_32x32x16_bf16 v[80:95], v[12:15], v[36:39], v[80:95]
    ds_read_b128 v[12:15], v2 offset:29696
    v_exp_f32 v72, v72
    v_exp_f32 v73, v73
    v_exp_f32 v74, v74
    s_waitcnt lgkmcnt(3)
    v_smfmac_f32_32x32x32_bf16 v[128:143], v[16:19], v[64:71], v4
    v_exp_f32 v75, v75
    v_exp_f32 v76, v76
    v_exp_f32 v77, v77
    v_exp_f32 v78, v78
    v_exp_f32 v79, v79
    v_smfmac_f32_16x16x64_bf16 v[60:63], v[56:59], v[64:71], v4
    v_exp_f32 v80, v80
    s_waitcnt lgkmcnt(2)
    v_smfmac_f32_32x32x32_bf16 v[128:143], v[20:23], v[72:79], v4
    v_exp_f32 v81, v81
    v_exp_f32 v82, v82
    v_exp_f32 v83, v83
    v_smfmac_f32_16x16x64_bf16 v[60:63], v[56:59], v[72:79], v4
    v_exp_f32 v84, v84
    s_waitcnt lgkmcnt(1)
    v_mfma_f32_32x32x16_bf16 v[64:79], v[8:11], v[24:27], v[96:111]
    v_exp_f32 v85, v85
    v_exp_f32 v86, v86
    v_exp_f32 v87, v87
    s_waitcnt lgkmcnt(0)
    v_mfma_f32_32x32x16_bf16 v[64:79], v[12:15], v[28:31], v[64:79]
    v_exp_f32 v88, v88
    v_exp_f32 v89, v89
    v_exp_f32 v90, v90
    v_smfmac_f32_32x32x32_bf16 v[144:159], v[16:19], v[80:87], v4
    ds_read_b128 v[16:19], v2 offset:30720
    v_exp_f32 v91, v91
    v_exp_f32 v92, v92
    v_exp_f32 v93, v93
    v_exp_f32 v94, v94
    v_exp_f32 v95, v95
    v_smfmac_f32_16x16x64_bf16 v[160:163], v[56:59], v[80:87], v4
    s_nop 0
    v_exp_f32 v64, v64
    v_smfmac_f32_32x32x32_bf16 v[144:159], v[20:23], v[88:95], v4
    ds_read_b128 v[20:23], v2 offset:31744
    v_exp_f32 v65, v65
    v_exp_f32 v66, v66
    v_exp_f32 v67, v67
    v_smfmac_f32_16x16x64_bf16 v[160:163], v[56:59], v[88:95], v4
    v_exp_f32 v68, v68
    v_mfma_f32_32x32x16_bf16 v[80:95], v[8:11], v[32:35], v[112:127]
    s_cmp_eq_u32 s40, 1
    s_cbranch_scc1 concat_heads__softmax_full_mha__mha_block__prompt_kernel_nobar7xb
    s_barrier
concat_heads__softmax_full_mha__mha_block__prompt_kernel_nobar7xb:
    ds_read_b128 v[8:11], v3 offset:0
    v_exp_f32 v69, v69
    v_exp_f32 v70, v70
    v_exp_f32 v71, v71
    v_mfma_f32_32x32x16_bf16 v[80:95], v[12:15], v[36:39], v[80:95]
    ds_read_b128 v[12:15], v3 offset:1024
    v_exp_f32 v72, v72
    v_exp_f32 v73, v73
    v_exp_f32 v74, v74
    s_waitcnt lgkmcnt(3)
    v_smfmac_f32_32x32x32_bf16 v[128:143], v[16:19], v[64:71], v4
    v_exp_f32 v75, v75
    v_exp_f32 v76, v76
    v_exp_f32 v77, v77
    v_exp_f32 v78, v78
    v_exp_f32 v79, v79
    v_smfmac_f32_16x16x64_bf16 v[60:63], v[56:59], v[64:71], v4
    v_exp_f32 v80, v80
    s_waitcnt lgkmcnt(2)
    v_smfmac_f32_32x32x32_bf16 v[128:143], v[20:23], v[72:79], v4
    v_exp_f32 v81, v81
    v_exp_f32 v82, v82
    v_exp_f32 v83, v83
    v_smfmac_f32_16x16x64_bf16 v[60:63], v[56:59], v[72:79], v4
    v_exp_f32 v84, v84
    s_waitcnt lgkmcnt(1)
    v_mfma_f32_32x32x16_bf16 v[64:79], v[8:11], v[24:27], v[96:111]
    v_exp_f32 v85, v85
    v_exp_f32 v86, v86
    v_exp_f32 v87, v87
    s_waitcnt lgkmcnt(0)
    v_mfma_f32_32x32x16_bf16 v[64:79], v[12:15], v[28:31], v[64:79]
    v_exp_f32 v88, v88
    v_exp_f32 v89, v89
    v_exp_f32 v90, v90
    v_smfmac_f32_32x32x32_bf16 v[144:159], v[16:19], v[80:87], v4
    ds_read_b128 v[16:19], v3 offset:2048
    v_exp_f32 v91, v91
    v_exp_f32 v92, v92
    v_exp_f32 v93, v93
    v_exp_f32 v94, v94
    v_exp_f32 v95, v95
    v_smfmac_f32_16x16x64_bf16 v[160:163], v[56:59], v[80:87], v4
    v_xor_b32 v2, 0x8000, v2
    v_xor_b32 v3, 0x8000, v3
    s_sub_u32 s40, s40, 1
    s_cmp_lg_u32 s40, 0
    s_cbranch_scc1 concat_heads__softmax_full_mha__mha_block__prompt_kernel_atloopb
concat_heads__softmax_full_mha__mha_block__prompt_kernel_atdone:
    s_setprio 3
    s_waitcnt lgkmcnt(0)
    v_smfmac_f32_32x32x32_bf16 v[144:159], v[20:23], v[88:95], v4
    v_smfmac_f32_16x16x64_bf16 v[160:163], v[56:59], v[88:95], v4
    v_mov_b32 v61, v60
    s_nop 1
    v_permlane32_swap_b32 v60, v61
    s_nop 0
concat_heads__softmax_full_mha__mha_block__prompt_kernel_norm0:
    v_rcp_f32 v62, v60
    s_nop 0
    v_pk_mul_f32 v[128:129], v[128:129], v[62:63] op_sel_hi:[1,0]
    v_pk_mul_f32 v[130:131], v[130:131], v[62:63] op_sel_hi:[1,0]
    v_pk_mul_f32 v[132:133], v[132:133], v[62:63] op_sel_hi:[1,0]
    v_pk_mul_f32 v[134:135], v[134:135], v[62:63] op_sel_hi:[1,0]
    v_pk_mul_f32 v[136:137], v[136:137], v[62:63] op_sel_hi:[1,0]
    v_pk_mul_f32 v[138:139], v[138:139], v[62:63] op_sel_hi:[1,0]
    v_pk_mul_f32 v[140:141], v[140:141], v[62:63] op_sel_hi:[1,0]
    v_pk_mul_f32 v[142:143], v[142:143], v[62:63] op_sel_hi:[1,0]
    v_cvt_pk_bf16_f32 v64, v128, v129
    v_cvt_pk_bf16_f32 v65, v130, v131
    v_cvt_pk_bf16_f32 v66, v132, v133
    v_cvt_pk_bf16_f32 v67, v134, v135
    buffer_store_dwordx4 v[64:67], v47, s[80:83], 0 offen sc1
    v_cvt_pk_bf16_f32 v68, v136, v137
    v_cvt_pk_bf16_f32 v69, v138, v139
    v_cvt_pk_bf16_f32 v70, v140, v141
    v_cvt_pk_bf16_f32 v71, v142, v143
    buffer_store_dwordx4 v[68:71], v47, s[80:83], 0 offen offset:512 sc1
    s_cmp_lg_u32 s91, 0
    s_cbranch_scc1 concat_heads__softmax_full_mha__mha_block__prompt_kernel_norm1
    v_mov_b32 v161, v160
    s_nop 1
    v_permlane32_swap_b32 v160, v161
    s_nop 0
concat_heads__softmax_full_mha__mha_block__prompt_kernel_norm1:
    v_rcp_f32 v162, v160
    s_nop 0
    v_pk_mul_f32 v[144:145], v[144:145], v[162:163] op_sel_hi:[1,0]
    v_pk_mul_f32 v[146:147], v[146:147], v[162:163] op_sel_hi:[1,0]
    v_pk_mul_f32 v[148:149], v[148:149], v[162:163] op_sel_hi:[1,0]
    v_pk_mul_f32 v[150:151], v[150:151], v[162:163] op_sel_hi:[1,0]
    v_pk_mul_f32 v[152:153], v[152:153], v[162:163] op_sel_hi:[1,0]
    v_pk_mul_f32 v[154:155], v[154:155], v[162:163] op_sel_hi:[1,0]
    v_pk_mul_f32 v[156:157], v[156:157], v[162:163] op_sel_hi:[1,0]
    v_pk_mul_f32 v[158:159], v[158:159], v[162:163] op_sel_hi:[1,0]
    v_cvt_pk_bf16_f32 v72, v144, v145
    v_cvt_pk_bf16_f32 v73, v146, v147
    v_cvt_pk_bf16_f32 v74, v148, v149
    v_cvt_pk_bf16_f32 v75, v150, v151
    buffer_store_dwordx4 v[72:75], v47, s[80:83], s90 offen sc1
    v_cvt_pk_bf16_f32 v76, v152, v153
    v_cvt_pk_bf16_f32 v77, v154, v155
    v_cvt_pk_bf16_f32 v78, v156, v157
    v_cvt_pk_bf16_f32 v79, v158, v159
    buffer_store_dwordx4 v[76:79], v47, s[80:83], s90 offen offset:512 sc1
    s_cmp_lg_u32 s91, 0
    s_cbranch_scc1 concat_heads__softmax_full_mha__mha_block__prompt_kernel_guarded
    v_pk_mul_f32 v[80:81], v[128:129], 0
    v_pk_mul_f32 v[82:83], v[144:145], 0
    v_pk_fma_f32 v[80:81], v[130:131], 0, v[80:81]
    v_pk_fma_f32 v[82:83], v[146:147], 0, v[82:83]
    v_pk_fma_f32 v[80:81], v[132:133], 0, v[80:81]
    v_pk_fma_f32 v[82:83], v[148:149], 0, v[82:83]
    v_pk_fma_f32 v[80:81], v[134:135], 0, v[80:81]
    v_pk_fma_f32 v[82:83], v[150:151], 0, v[82:83]
    v_pk_fma_f32 v[80:81], v[136:137], 0, v[80:81]
    v_pk_fma_f32 v[82:83], v[152:153], 0, v[82:83]
    v_pk_fma_f32 v[80:81], v[138:139], 0, v[80:81]
    v_pk_fma_f32 v[82:83], v[154:155], 0, v[82:83]
    v_pk_fma_f32 v[80:81], v[140:141], 0, v[80:81]
    v_pk_fma_f32 v[82:83], v[156:157], 0, v[82:83]
    v_pk_fma_f32 v[80:81], v[142:143], 0, v[80:81]
    v_pk_fma_f32 v[82:83], v[158:159], 0, v[82:83]
    v_pk_add_f32 v[80:81], v[80:81], v[82:83]
    v_add_f32 v1, v60, v160
    v_add_f32 v1, v1, v80
    v_add_f32 v1, v1, v81
    v_cmp_nge_f32 vcc, 0x5d800000, v1
    s_nop 4
    s_cbranch_vccnz concat_heads__softmax_full_mha__mha_block__prompt_kernel_slow
concat_heads__softmax_full_mha__mha_block__prompt_kernel_guarded:
    s_waitcnt vmcnt(0)
    s_mov_b64 exec, 1
    global_store_dwordx2 v46, v[44:45], s[44:45] sc1
    s_mov_b64 exec, -1
    s_cmp_lt_u32 s18, 4
    s_cbranch_scc1 concat_heads__softmax_full_mha__mha_block__prompt_kernel_cdone
    s_setprio 0
    v_mov_b64 v[88:89], 0
    v_mov_b64 v[90:91], 0
    v_mov_b64 v[92:93], 0
    v_mov_b64 v[94:95], 0
    v_mov_b64 v[96:97], 0
    v_mov_b64 v[98:99], 0
    v_mov_b64 v[100:101], 0
    v_mov_b64 v[102:103], 0
    v_mov_b64 v[104:105], 0
    v_mov_b64 v[106:107], 0
    v_mov_b64 v[108:109], 0
    v_mov_b64 v[110:111], 0
    v_mov_b64 v[112:113], 0
    v_mov_b64 v[114:115], 0
    v_mov_b64 v[116:117], 0
    v_mov_b64 v[118:119], 0
    v_mov_b64 v[120:121], 0
    v_mov_b64 v[122:123], 0
    v_mov_b64 v[124:125], 0
    v_mov_b64 v[126:127], 0
    v_mov_b64 v[128:129], 0
    v_mov_b64 v[130:131], 0
    v_mov_b64 v[132:133], 0
    v_mov_b64 v[134:135], 0
    v_mov_b64 v[136:137], 0
    v_mov_b64 v[138:139], 0
    v_mov_b64 v[140:141], 0
    v_mov_b64 v[142:143], 0
    v_mov_b64 v[144:145], 0
    v_mov_b64 v[146:147], 0
    v_mov_b64 v[148:149], 0
    v_mov_b64 v[150:151], 0
    s_mov_b32 s32, 32768
    s_mov_b32 s33, 98304
    s_barrier
    ds_read_b64_tr_b16 v[56:57], v40 offset:0
    ds_read_b64_tr_b16 v[58:59], v40 offset:2048
    ds_read_b128 v[8:11], v48 offset:0
    ds_read_b128 v[12:15], v48 offset:1024
    ds_read_b128 v[16:19], v48 offset:4096
    ds_read_b128 v[20:23], v48 offset:5120
    ds_read_b64_tr_b16 v[60:61], v41 offset:0
    ds_read_b64_tr_b16 v[62:63], v41 offset:2048
    ds_read_b64_tr_b16 v[64:65], v42 offset:0
    ds_read_b64_tr_b16 v[66:67], v42 offset:2048
    ds_read_b64_tr_b16 v[68:69], v43 offset:0
    ds_read_b64_tr_b16 v[70:71], v43 offset:2048
    s_waitcnt lgkmcnt(9)
    v_mfma_f32_16x16x32_bf16 v[88:91], v[56:59], v[8:11], v[88:91]
    s_waitcnt lgkmcnt(8)
    v_mfma_f32_16x16x32_bf16 v[92:95], v[56:59], v[12:15], v[92:95]
    ds_read_b64_tr_b16 v[72:73], v40 offset:8192
    s_waitcnt lgkmcnt(8)
    v_mfma_f32_16x16x32_bf16 v[96:99], v[56:59], v[16:19], v[96:99]
    ds_read_b64_tr_b16 v[74:75], v40 offset:10240
    s_waitcnt lgkmcnt(8)
    v_mfma_f32_16x16x32_bf16 v[100:103], v[56:59], v[20:23], v[100:103]
    ds_read_b128 v[24:27], v48 offset:2048
    s_waitcnt lgkmcnt(7)
    v_mfma_f32_16x16x32_bf16 v[104:107], v[60:63], v[8:11], v[104:107]
    ds_read_b128 v[28:31], v48 offset:3072
    v_mfma_f32_16x16x32_bf16 v[108:111], v[60:63], v[12:15], v[108:111]
    ds_read_b128 v[32:35], v48 offset:6144
    v_mfma_f32_16x16x32_bf16 v[112:115], v[60:63], v[16:19], v[112:115]
    ds_read_b128 v[36:39], v48 offset:7168
    v_mfma_f32_16x16x32_bf16 v[116:119], v[60:63], v[20:23], v[116:119]
    ds_read_b64_tr_b16 v[76:77], v41 offset:8192
    s_waitcnt lgkmcnt(9)
    v_mfma_f32_16x16x32_bf16 v[120:123], v[64:67], v[8:11], v[120:123]
    ds_read_b64_tr_b16 v[78:79], v41 offset:10240
    v_mfma_f32_16x16x32_bf16 v[124:127], v[64:67], v[12:15], v[124:127]
    ds_read_b64_tr_b16 v[80:81], v42 offset:8192
    v_mfma_f32_16x16x32_bf16 v[128:131], v[64:67], v[16:19], v[128:131]
    ds_read_b64_tr_b16 v[82:83], v42 offset:10240
    v_mfma_f32_16x16x32_bf16 v[132:135], v[64:67], v[20:23], v[132:135]
    ds_read_b64_tr_b16 v[84:85], v43 offset:8192
    s_waitcnt lgkmcnt(11)
    v_mfma_f32_16x16x32_bf16 v[136:139], v[68:71], v[8:11], v[136:139]
    ds_read_b64_tr_b16 v[86:87], v43 offset:10240
    v_mfma_f32_16x16x32_bf16 v[140:143], v[68:71], v[12:15], v[140:143]
    v_mfma_f32_16x16x32_bf16 v[144:147], v[68:71], v[16:19], v[144:147]
    s_cmp_ge_u32 s32, 65536
    s_cselect_b32 s34, 4294901760, s33
    s_add_u32 s32, s32, s34
    v_mfma_f32_16x16x32_bf16 v[148:151], v[68:71], v[20:23], v[148:151]
    s_mov_b32 s40, 15
.p2align 6
concat_heads__softmax_full_mha__mha_block__prompt_kernel_g3loop:
    s_waitcnt lgkmcnt(9)
    v_mfma_f32_16x16x32_bf16 v[88:91], v[72:75], v[24:27], v[88:91]
    s_waitcnt lgkmcnt(0)
    s_barrier
    v_add_u32 v40, s34, v40
    v_add_u32 v48, s34, v48
    v_mfma_f32_16x16x32_bf16 v[92:95], v[72:75], v[28:31], v[92:95]
    v_add_u32 v41, s34, v41
    v_add_u32 v42, s34, v42
    v_add_u32 v43, s34, v43
    ds_read_b64_tr_b16 v[56:57], v40 offset:0
    v_mfma_f32_16x16x32_bf16 v[96:99], v[72:75], v[32:35], v[96:99]
    ds_read_b64_tr_b16 v[58:59], v40 offset:2048
    v_mfma_f32_16x16x32_bf16 v[100:103], v[72:75], v[36:39], v[100:103]
    ds_read_b128 v[8:11], v48 offset:0
    v_mfma_f32_16x16x32_bf16 v[104:107], v[76:79], v[24:27], v[104:107]
    ds_read_b128 v[12:15], v48 offset:1024
    v_mfma_f32_16x16x32_bf16 v[108:111], v[76:79], v[28:31], v[108:111]
    ds_read_b128 v[16:19], v48 offset:4096
    v_mfma_f32_16x16x32_bf16 v[112:115], v[76:79], v[32:35], v[112:115]
    ds_read_b128 v[20:23], v48 offset:5120
    v_mfma_f32_16x16x32_bf16 v[116:119], v[76:79], v[36:39], v[116:119]
    ds_read_b64_tr_b16 v[60:61], v41 offset:0
    v_mfma_f32_16x16x32_bf16 v[120:123], v[80:83], v[24:27], v[120:123]
    ds_read_b64_tr_b16 v[62:63], v41 offset:2048
    v_mfma_f32_16x16x32_bf16 v[124:127], v[80:83], v[28:31], v[124:127]
    ds_read_b64_tr_b16 v[64:65], v42 offset:0
    v_mfma_f32_16x16x32_bf16 v[128:131], v[80:83], v[32:35], v[128:131]
    ds_read_b64_tr_b16 v[66:67], v42 offset:2048
    v_mfma_f32_16x16x32_bf16 v[132:135], v[80:83], v[36:39], v[132:135]
    ds_read_b64_tr_b16 v[68:69], v43 offset:0
    v_mfma_f32_16x16x32_bf16 v[136:139], v[84:87], v[24:27], v[136:139]
    ds_read_b64_tr_b16 v[70:71], v43 offset:2048
    v_mfma_f32_16x16x32_bf16 v[140:143], v[84:87], v[28:31], v[140:143]
    v_mfma_f32_16x16x32_bf16 v[144:147], v[84:87], v[32:35], v[144:147]
    v_mfma_f32_16x16x32_bf16 v[148:151], v[84:87], v[36:39], v[148:151]
    s_waitcnt lgkmcnt(9)
    v_mfma_f32_16x16x32_bf16 v[88:91], v[56:59], v[8:11], v[88:91]
    s_waitcnt lgkmcnt(8)
    v_mfma_f32_16x16x32_bf16 v[92:95], v[56:59], v[12:15], v[92:95]
    ds_read_b64_tr_b16 v[72:73], v40 offset:8192
    s_waitcnt lgkmcnt(8)
    v_mfma_f32_16x16x32_bf16 v[96:99], v[56:59], v[16:19], v[96:99]
    ds_read_b64_tr_b16 v[74:75], v40 offset:10240
    s_waitcnt lgkmcnt(8)
    v_mfma_f32_16x16x32_bf16 v[100:103], v[56:59], v[20:23], v[100:103]
    ds_read_b128 v[24:27], v48 offset:2048
    s_waitcnt lgkmcnt(7)
    v_mfma_f32_16x16x32_bf16 v[104:107], v[60:63], v[8:11], v[104:107]
    ds_read_b128 v[28:31], v48 offset:3072
    v_mfma_f32_16x16x32_bf16 v[108:111], v[60:63], v[12:15], v[108:111]
    ds_read_b128 v[32:35], v48 offset:6144
    v_mfma_f32_16x16x32_bf16 v[112:115], v[60:63], v[16:19], v[112:115]
    ds_read_b128 v[36:39], v48 offset:7168
    v_mfma_f32_16x16x32_bf16 v[116:119], v[60:63], v[20:23], v[116:119]
    ds_read_b64_tr_b16 v[76:77], v41 offset:8192
    s_waitcnt lgkmcnt(9)
    v_mfma_f32_16x16x32_bf16 v[120:123], v[64:67], v[8:11], v[120:123]
    ds_read_b64_tr_b16 v[78:79], v41 offset:10240
    v_mfma_f32_16x16x32_bf16 v[124:127], v[64:67], v[12:15], v[124:127]
    ds_read_b64_tr_b16 v[80:81], v42 offset:8192
    v_mfma_f32_16x16x32_bf16 v[128:131], v[64:67], v[16:19], v[128:131]
    ds_read_b64_tr_b16 v[82:83], v42 offset:10240
    v_mfma_f32_16x16x32_bf16 v[132:135], v[64:67], v[20:23], v[132:135]
    ds_read_b64_tr_b16 v[84:85], v43 offset:8192
    s_waitcnt lgkmcnt(11)
    v_mfma_f32_16x16x32_bf16 v[136:139], v[68:71], v[8:11], v[136:139]
    ds_read_b64_tr_b16 v[86:87], v43 offset:10240
    v_mfma_f32_16x16x32_bf16 v[140:143], v[68:71], v[12:15], v[140:143]
    v_mfma_f32_16x16x32_bf16 v[144:147], v[68:71], v[16:19], v[144:147]
    s_cmp_ge_u32 s32, 65536
    s_cselect_b32 s34, 4294901760, s33
    s_add_u32 s32, s32, s34
    v_mfma_f32_16x16x32_bf16 v[148:151], v[68:71], v[20:23], v[148:151]
    s_sub_u32 s40, s40, 1
    s_cmp_lg_u32 s40, 0
    s_cbranch_scc1 concat_heads__softmax_full_mha__mha_block__prompt_kernel_g3loop
    s_waitcnt lgkmcnt(9)
    v_mfma_f32_16x16x32_bf16 v[88:91], v[72:75], v[24:27], v[88:91]
    s_waitcnt lgkmcnt(4)
    v_mfma_f32_16x16x32_bf16 v[104:107], v[76:79], v[24:27], v[104:107]
    s_waitcnt lgkmcnt(2)
    v_mfma_f32_16x16x32_bf16 v[120:123], v[80:83], v[24:27], v[120:123]
    s_waitcnt lgkmcnt(0)
    v_mfma_f32_16x16x32_bf16 v[136:139], v[84:87], v[24:27], v[136:139]
    v_mfma_f32_16x16x32_bf16 v[92:95], v[72:75], v[28:31], v[92:95]
    v_mfma_f32_16x16x32_bf16 v[108:111], v[76:79], v[28:31], v[108:111]
    v_mfma_f32_16x16x32_bf16 v[124:127], v[80:83], v[28:31], v[124:127]
    v_mfma_f32_16x16x32_bf16 v[140:143], v[84:87], v[28:31], v[140:143]
    v_mfma_f32_16x16x32_bf16 v[96:99], v[72:75], v[32:35], v[96:99]
    v_mfma_f32_16x16x32_bf16 v[112:115], v[76:79], v[32:35], v[112:115]
    v_mfma_f32_16x16x32_bf16 v[128:131], v[80:83], v[32:35], v[128:131]
    v_mfma_f32_16x16x32_bf16 v[144:147], v[84:87], v[32:35], v[144:147]
    v_mfma_f32_16x16x32_bf16 v[100:103], v[72:75], v[36:39], v[100:103]
    v_mfma_f32_16x16x32_bf16 v[116:119], v[76:79], v[36:39], v[116:119]
    v_mfma_f32_16x16x32_bf16 v[132:135], v[80:83], v[36:39], v[132:135]
    v_mfma_f32_16x16x32_bf16 v[148:151], v[84:87], v[36:39], v[148:151]
    s_mov_b32 s22, 0
    v_cvt_pk_bf16_f32 v8, v88, v89
    v_cvt_pk_bf16_f32 v9, v90, v91
    v_cvt_pk_bf16_f32 v10, v104, v105
    v_cvt_pk_bf16_f32 v11, v106, v107
    v_cvt_pk_bf16_f32 v12, v120, v121
    v_cvt_pk_bf16_f32 v13, v122, v123
    v_cvt_pk_bf16_f32 v14, v136, v137
    v_cvt_pk_bf16_f32 v15, v138, v139
    v_permlane16_swap_b32 v8, v10
    v_permlane16_swap_b32 v9, v11
    ds_write_b128 v50, v[8:11] offset:0
    v_permlane16_swap_b32 v12, v14
    v_permlane16_swap_b32 v13, v15
    ds_write_b128 v51, v[12:15] offset:0
    ds_read_b128 v[24:27], v52 offset:0
    ds_read_b128 v[28:31], v52 offset:1024
    v_cvt_pk_bf16_f32 v16, v92, v93
    v_cvt_pk_bf16_f32 v17, v94, v95
    v_cvt_pk_bf16_f32 v18, v108, v109
    v_cvt_pk_bf16_f32 v19, v110, v111
    v_cvt_pk_bf16_f32 v20, v124, v125
    v_cvt_pk_bf16_f32 v21, v126, v127
    v_cvt_pk_bf16_f32 v22, v140, v141
    v_cvt_pk_bf16_f32 v23, v142, v143
    v_permlane16_swap_b32 v16, v18
    v_permlane16_swap_b32 v17, v19
    ds_write_b128 v50, v[16:19] offset:2048
    v_permlane16_swap_b32 v20, v22
    v_permlane16_swap_b32 v21, v23
    ds_write_b128 v51, v[20:23] offset:2048
    ds_read_b128 v[32:35], v52 offset:2048
    ds_read_b128 v[36:39], v52 offset:3072
    s_waitcnt lgkmcnt(5)
    buffer_store_dwordx4 v[24:27], v49, s[84:87], s22 offen sc0 sc1
    s_add_u32 s22, s22, 32768
    s_waitcnt lgkmcnt(4)
    buffer_store_dwordx4 v[28:31], v49, s[84:87], s22 offen sc0 sc1
    s_add_u32 s22, s22, 32768
    v_cvt_pk_bf16_f32 v56, v96, v97
    v_cvt_pk_bf16_f32 v57, v98, v99
    v_cvt_pk_bf16_f32 v58, v112, v113
    v_cvt_pk_bf16_f32 v59, v114, v115
    v_cvt_pk_bf16_f32 v60, v128, v129
    v_cvt_pk_bf16_f32 v61, v130, v131
    v_cvt_pk_bf16_f32 v62, v144, v145
    v_cvt_pk_bf16_f32 v63, v146, v147
    v_permlane16_swap_b32 v56, v58
    v_permlane16_swap_b32 v57, v59
    ds_write_b128 v50, v[56:59] offset:4096
    v_permlane16_swap_b32 v60, v62
    v_permlane16_swap_b32 v61, v63
    ds_write_b128 v51, v[60:63] offset:4096
    ds_read_b128 v[72:75], v52 offset:4096
    ds_read_b128 v[76:79], v52 offset:5120
    s_waitcnt lgkmcnt(5)
    buffer_store_dwordx4 v[32:35], v49, s[84:87], s22 offen sc0 sc1
    s_add_u32 s22, s22, 32768
    s_waitcnt lgkmcnt(4)
    buffer_store_dwordx4 v[36:39], v49, s[84:87], s22 offen sc0 sc1
    s_add_u32 s22, s22, 32768
    v_cvt_pk_bf16_f32 v64, v100, v101
    v_cvt_pk_bf16_f32 v65, v102, v103
    v_cvt_pk_bf16_f32 v66, v116, v117
    v_cvt_pk_bf16_f32 v67, v118, v119
    v_cvt_pk_bf16_f32 v68, v132, v133
    v_cvt_pk_bf16_f32 v69, v134, v135
    v_cvt_pk_bf16_f32 v70, v148, v149
    v_cvt_pk_bf16_f32 v71, v150, v151
    v_permlane16_swap_b32 v64, v66
    v_permlane16_swap_b32 v65, v67
    ds_write_b128 v50, v[64:67] offset:6144
    v_permlane16_swap_b32 v68, v70
    v_permlane16_swap_b32 v69, v71
    ds_write_b128 v51, v[68:71] offset:6144
    ds_read_b128 v[80:83], v52 offset:6144
    ds_read_b128 v[84:87], v52 offset:7168
    s_waitcnt lgkmcnt(5)
    buffer_store_dwordx4 v[72:75], v49, s[84:87], s22 offen sc0 sc1
    s_add_u32 s22, s22, 32768
    s_waitcnt lgkmcnt(4)
    buffer_store_dwordx4 v[76:79], v49, s[84:87], s22 offen sc0 sc1
    s_add_u32 s22, s22, 32768
    s_waitcnt lgkmcnt(1)
    buffer_store_dwordx4 v[80:83], v49, s[84:87], s22 offen sc0 sc1
    s_add_u32 s22, s22, 32768
    s_waitcnt lgkmcnt(0)
    buffer_store_dwordx4 v[84:87], v49, s[84:87], s22 offen sc0 sc1
concat_heads__softmax_full_mha__mha_block__prompt_kernel_cdone:
    s_endpgm
concat_heads__softmax_full_mha__mha_block__prompt_kernel_mida:
    v_mov_b32 v53, 0
    global_load_dwordx2 v[44:45], v53, s[14:15] sc1
    v_mov_b32 v46, s88
    v_bfe_u32 v53, v0, 3, 2
    v_lshlrev_b32 v53, 11, v53
    v_and_b32 v54, 7, v0
    v_lshl_add_u32 v53, v54, 7, v53
    buffer_load_dword v6, v53, s[24:27], s39 offen
    v_bfe_u32 v53, v0, 4, 1
    v_lshlrev_b32 v53, 10, v53
    v_lshrrev_b32 v54, 5, v0
    v_lshl_add_u32 v53, v54, 8, v53
    v_and_b32 v54, 15, v0
    v_lshl_add_u32 v47, v54, 4, v53
    s_branch concat_heads__softmax_full_mha__mha_block__prompt_kernel_midreta
concat_heads__softmax_full_mha__mha_block__prompt_kernel_midb:
    v_mov_b32 v53, 0
    global_load_dwordx2 v[44:45], v53, s[14:15] sc1
    v_mov_b32 v46, s88
    v_bfe_u32 v53, v0, 3, 2
    v_lshlrev_b32 v53, 11, v53
    v_and_b32 v54, 7, v0
    v_lshl_add_u32 v53, v54, 7, v53
    buffer_load_dword v6, v53, s[24:27], s39 offen
    v_bfe_u32 v53, v0, 4, 1
    v_lshlrev_b32 v53, 10, v53
    v_lshrrev_b32 v54, 5, v0
    v_lshl_add_u32 v53, v54, 8, v53
    v_and_b32 v54, 15, v0
    v_lshl_add_u32 v47, v54, 4, v53
    s_and_b32 s22, s18, 1
    s_lshl_b32 s22, s22, 13
    s_add_u32 s22, s22, 32768
    v_lshlrev_b32 v48, 4, v0
    v_add_u32 v48, s22, v48
    v_bfe_u32 v53, v0, 2, 3
    s_and_b32 s22, s18, 2
    s_lshl_b32 s22, s22, 1
    v_xor_b32 v54, s22, v53
    v_lshlrev_b32 v54, 5, v54
    v_lshl_add_u32 v54, v53, 8, v54
    v_lshrrev_b32 v53, 5, v0
    v_lshl_add_u32 v54, v53, 12, v54
    v_and_b32 v53, 3, v0
    v_lshl_add_u32 v54, v53, 3, v54
    v_add_u32 v40, 49152, v54
    v_xor_b32 v41, 32, v40
    v_xor_b32 v42, 64, v40
    v_xor_b32 v43, 96, v40
    s_and_b32 s22, s18, 3
    s_lshl_b32 s22, s22, 13
    s_add_u32 s22, s22, 98304
    v_bfe_u32 v53, v0, 4, 1
    v_lshrrev_b32 v54, 5, v0
    v_lshl_add_u32 v53, v53, 1, v54
    v_and_b32 v54, 7, v0
    v_xor_b32 v53, v53, v54
    v_lshlrev_b32 v53, 4, v53
    v_and_b32 v52, 15, v0
    v_lshl_add_u32 v53, v52, 7, v53
    v_add_u32 v50, s22, v53
    v_xor_b32 v51, 64, v50
    v_lshrrev_b32 v53, 3, v0
    v_lshlrev_b32 v49, 12, v53
    v_lshl_add_u32 v49, v54, 4, v49
    v_xor_b32 v54, v53, v54
    v_lshlrev_b32 v54, 4, v54
    v_lshl_add_u32 v54, v53, 7, v54
    v_add_u32 v52, s22, v54
    s_branch concat_heads__softmax_full_mha__mha_block__prompt_kernel_midretb
concat_heads__softmax_full_mha__mha_block__prompt_kernel_slow:
    s_mov_b32 s91, 1
    s_lshl_b32 s22, s19, 5
    s_add_u32 s22, s22, s89
    s_lshl_b32 s22, s22, 18
    s_add_u32 s22, s22, 8388608
    s_add_u32 s28, s16, s22
    s_addc_u32 s29, s17, 0
    s_mov_b32 s30, 262144
    s_mov_b32 s31, 0x20000
    v_lshlrev_b32 v101, 4, v0
    v_mov_b32 v96, 0xff7fffff
    v_mov_b32 v60, 0
    v_mov_b32 v128, 0
    v_mov_b32 v129, 0
    v_mov_b32 v130, 0
    v_mov_b32 v131, 0
    v_mov_b32 v132, 0
    v_mov_b32 v133, 0
    v_mov_b32 v134, 0
    v_mov_b32 v135, 0
    v_mov_b32 v136, 0
    v_mov_b32 v137, 0
    v_mov_b32 v138, 0
    v_mov_b32 v139, 0
    v_mov_b32 v140, 0
    v_mov_b32 v141, 0
    v_mov_b32 v142, 0
    v_mov_b32 v143, 0
    v_mov_b32 v97, 0xff7fffff
    v_mov_b32 v160, 0
    v_mov_b32 v144, 0
    v_mov_b32 v145, 0
    v_mov_b32 v146, 0
    v_mov_b32 v147, 0
    v_mov_b32 v148, 0
    v_mov_b32 v149, 0
    v_mov_b32 v150, 0
    v_mov_b32 v151, 0
    v_mov_b32 v152, 0
    v_mov_b32 v153, 0
    v_mov_b32 v154, 0
    v_mov_b32 v155, 0
    v_mov_b32 v156, 0
    v_mov_b32 v157, 0
    v_mov_b32 v158, 0
    v_mov_b32 v159, 0
    s_mov_b32 s35, 0
concat_heads__softmax_full_mha__mha_block__prompt_kernel_slowloop:
    buffer_load_dwordx4 v[112:115], v101, s[28:31], s35 offen offset:0 sc1
    buffer_load_dwordx4 v[116:119], v101, s[28:31], s35 offen offset:1024 sc1
    buffer_load_dwordx4 v[120:123], v101, s[28:31], s35 offen offset:2048 sc1
    buffer_load_dwordx4 v[124:127], v101, s[28:31], s35 offen offset:3072 sc1
    s_waitcnt vmcnt(0)
    v_mfma_f32_32x32x16_bf16 v[64:79], v[112:115], v[24:27], 0
    v_mfma_f32_32x32x16_bf16 v[64:79], v[116:119], v[28:31], v[64:79]
    s_nop 15
    v_max3_f32 v99, v64, v65, v96
    v_max3_f32 v99, v99, v66, v67
    v_max3_f32 v99, v99, v68, v69
    v_max3_f32 v99, v99, v70, v71
    v_max3_f32 v99, v99, v72, v73
    v_max3_f32 v99, v99, v74, v75
    v_max3_f32 v99, v99, v76, v77
    v_max3_f32 v99, v99, v78, v79
    v_mov_b32 v100, v99
    s_nop 1
    v_permlane32_swap_b32 v99, v100
    s_nop 1
    v_max_f32 v99, v99, v100
    v_sub_f32 v98, v96, v99
    v_exp_f32 v98, v98
    v_mov_b32 v96, v99
    v_sub_f32 v64, v64, v99
    v_sub_f32 v65, v65, v99
    v_sub_f32 v66, v66, v99
    v_sub_f32 v67, v67, v99
    v_sub_f32 v68, v68, v99
    v_sub_f32 v69, v69, v99
    v_sub_f32 v70, v70, v99
    v_sub_f32 v71, v71, v99
    v_sub_f32 v72, v72, v99
    v_sub_f32 v73, v73, v99
    v_sub_f32 v74, v74, v99
    v_sub_f32 v75, v75, v99
    v_sub_f32 v76, v76, v99
    v_sub_f32 v77, v77, v99
    v_sub_f32 v78, v78, v99
    v_sub_f32 v79, v79, v99
    v_exp_f32 v64, v64
    v_exp_f32 v65, v65
    v_exp_f32 v66, v66
    v_exp_f32 v67, v67
    v_exp_f32 v68, v68
    v_exp_f32 v69, v69
    v_exp_f32 v70, v70
    v_exp_f32 v71, v71
    v_exp_f32 v72, v72
    v_exp_f32 v73, v73
    v_exp_f32 v74, v74
    v_exp_f32 v75, v75
    v_exp_f32 v76, v76
    v_exp_f32 v77, v77
    v_exp_f32 v78, v78
    v_exp_f32 v79, v79
    v_mul_f32 v60, v60, v98
    v_mul_f32 v128, v128, v98
    v_mul_f32 v129, v129, v98
    v_mul_f32 v130, v130, v98
    v_mul_f32 v131, v131, v98
    v_mul_f32 v132, v132, v98
    v_mul_f32 v133, v133, v98
    v_mul_f32 v134, v134, v98
    v_mul_f32 v135, v135, v98
    v_mul_f32 v136, v136, v98
    v_mul_f32 v137, v137, v98
    v_mul_f32 v138, v138, v98
    v_mul_f32 v139, v139, v98
    v_mul_f32 v140, v140, v98
    v_mul_f32 v141, v141, v98
    v_mul_f32 v142, v142, v98
    v_mul_f32 v143, v143, v98
    v_and_b32 v64, 0xffff0000, v64
    v_and_b32 v65, 0xffff0000, v65
    v_and_b32 v66, 0xffff0000, v66
    v_and_b32 v67, 0xffff0000, v67
    v_and_b32 v68, 0xffff0000, v68
    v_and_b32 v69, 0xffff0000, v69
    v_and_b32 v70, 0xffff0000, v70
    v_and_b32 v71, 0xffff0000, v71
    v_and_b32 v72, 0xffff0000, v72
    v_and_b32 v73, 0xffff0000, v73
    v_and_b32 v74, 0xffff0000, v74
    v_and_b32 v75, 0xffff0000, v75
    v_and_b32 v76, 0xffff0000, v76
    v_and_b32 v77, 0xffff0000, v77
    v_and_b32 v78, 0xffff0000, v78
    v_and_b32 v79, 0xffff0000, v79
    v_add_f32 v60, v60, v64
    v_add_f32 v60, v60, v65
    v_add_f32 v60, v60, v66
    v_add_f32 v60, v60, v67
    v_add_f32 v60, v60, v68
    v_add_f32 v60, v60, v69
    v_add_f32 v60, v60, v70
    v_add_f32 v60, v60, v71
    v_add_f32 v60, v60, v72
    v_add_f32 v60, v60, v73
    v_add_f32 v60, v60, v74
    v_add_f32 v60, v60, v75
    v_add_f32 v60, v60, v76
    v_add_f32 v60, v60, v77
    v_add_f32 v60, v60, v78
    v_add_f32 v60, v60, v79
    s_nop 1
    v_smfmac_f32_32x32x32_bf16 v[128:143], v[120:123], v[64:71], v4
    v_smfmac_f32_32x32x32_bf16 v[128:143], v[124:127], v[72:79], v4
    v_mfma_f32_32x32x16_bf16 v[80:95], v[112:115], v[32:35], 0
    v_mfma_f32_32x32x16_bf16 v[80:95], v[116:119], v[36:39], v[80:95]
    s_nop 15
    v_max3_f32 v99, v80, v81, v97
    v_max3_f32 v99, v99, v82, v83
    v_max3_f32 v99, v99, v84, v85
    v_max3_f32 v99, v99, v86, v87
    v_max3_f32 v99, v99, v88, v89
    v_max3_f32 v99, v99, v90, v91
    v_max3_f32 v99, v99, v92, v93
    v_max3_f32 v99, v99, v94, v95
    v_mov_b32 v100, v99
    s_nop 1
    v_permlane32_swap_b32 v99, v100
    s_nop 1
    v_max_f32 v99, v99, v100
    v_sub_f32 v98, v97, v99
    v_exp_f32 v98, v98
    v_mov_b32 v97, v99
    v_sub_f32 v80, v80, v99
    v_sub_f32 v81, v81, v99
    v_sub_f32 v82, v82, v99
    v_sub_f32 v83, v83, v99
    v_sub_f32 v84, v84, v99
    v_sub_f32 v85, v85, v99
    v_sub_f32 v86, v86, v99
    v_sub_f32 v87, v87, v99
    v_sub_f32 v88, v88, v99
    v_sub_f32 v89, v89, v99
    v_sub_f32 v90, v90, v99
    v_sub_f32 v91, v91, v99
    v_sub_f32 v92, v92, v99
    v_sub_f32 v93, v93, v99
    v_sub_f32 v94, v94, v99
    v_sub_f32 v95, v95, v99
    v_exp_f32 v80, v80
    v_exp_f32 v81, v81
    v_exp_f32 v82, v82
    v_exp_f32 v83, v83
    v_exp_f32 v84, v84
    v_exp_f32 v85, v85
    v_exp_f32 v86, v86
    v_exp_f32 v87, v87
    v_exp_f32 v88, v88
    v_exp_f32 v89, v89
    v_exp_f32 v90, v90
    v_exp_f32 v91, v91
    v_exp_f32 v92, v92
    v_exp_f32 v93, v93
    v_exp_f32 v94, v94
    v_exp_f32 v95, v95
    v_mul_f32 v160, v160, v98
    v_mul_f32 v144, v144, v98
    v_mul_f32 v145, v145, v98
    v_mul_f32 v146, v146, v98
    v_mul_f32 v147, v147, v98
    v_mul_f32 v148, v148, v98
    v_mul_f32 v149, v149, v98
    v_mul_f32 v150, v150, v98
    v_mul_f32 v151, v151, v98
    v_mul_f32 v152, v152, v98
    v_mul_f32 v153, v153, v98
    v_mul_f32 v154, v154, v98
    v_mul_f32 v155, v155, v98
    v_mul_f32 v156, v156, v98
    v_mul_f32 v157, v157, v98
    v_mul_f32 v158, v158, v98
    v_mul_f32 v159, v159, v98
    v_and_b32 v80, 0xffff0000, v80
    v_and_b32 v81, 0xffff0000, v81
    v_and_b32 v82, 0xffff0000, v82
    v_and_b32 v83, 0xffff0000, v83
    v_and_b32 v84, 0xffff0000, v84
    v_and_b32 v85, 0xffff0000, v85
    v_and_b32 v86, 0xffff0000, v86
    v_and_b32 v87, 0xffff0000, v87
    v_and_b32 v88, 0xffff0000, v88
    v_and_b32 v89, 0xffff0000, v89
    v_and_b32 v90, 0xffff0000, v90
    v_and_b32 v91, 0xffff0000, v91
    v_and_b32 v92, 0xffff0000, v92
    v_and_b32 v93, 0xffff0000, v93
    v_and_b32 v94, 0xffff0000, v94
    v_and_b32 v95, 0xffff0000, v95
    v_add_f32 v160, v160, v80
    v_add_f32 v160, v160, v81
    v_add_f32 v160, v160, v82
    v_add_f32 v160, v160, v83
    v_add_f32 v160, v160, v84
    v_add_f32 v160, v160, v85
    v_add_f32 v160, v160, v86
    v_add_f32 v160, v160, v87
    v_add_f32 v160, v160, v88
    v_add_f32 v160, v160, v89
    v_add_f32 v160, v160, v90
    v_add_f32 v160, v160, v91
    v_add_f32 v160, v160, v92
    v_add_f32 v160, v160, v93
    v_add_f32 v160, v160, v94
    v_add_f32 v160, v160, v95
    s_nop 1
    v_smfmac_f32_32x32x32_bf16 v[144:159], v[120:123], v[80:87], v4
    v_smfmac_f32_32x32x32_bf16 v[144:159], v[124:127], v[88:95], v4
    s_nop 15
    s_add_u32 s35, s35, 4096
    s_cmp_lt_u32 s35, 262144
    s_cbranch_scc1 concat_heads__softmax_full_mha__mha_block__prompt_kernel_slowloop
    v_mov_b32 v100, v60
    s_nop 1
    v_permlane32_swap_b32 v60, v100
    s_nop 1
    v_add_f32 v60, v60, v100
    v_mov_b32 v100, v160
    s_nop 1
    v_permlane32_swap_b32 v160, v100
    s_nop 1
    v_add_f32 v160, v160, v100
    s_branch concat_heads__softmax_full_mha__mha_block__prompt_kernel_norm0
.section .rodata,"a"
.p2align 6
.amdhsa_kernel concat_heads__softmax_full_mha__mha_block__prompt_kernel
  .amdhsa_next_free_vgpr 168
  .amdhsa_next_free_sgpr 96
  .amdhsa_accum_offset 168
  .amdhsa_group_segment_fixed_size 0
  .amdhsa_kernarg_size 72
  .amdhsa_user_sgpr_count 2
  .amdhsa_user_sgpr_kernarg_segment_ptr 1
  .amdhsa_system_sgpr_workgroup_id_x 1
.end_amdhsa_kernel
.text
```
